```python
import torch

def _softmax(x, axis=-1):
    return torch.softmax(x, dim=axis)
def _gelu(x):
    return torch.nn.functional.gelu(x, approximate="tanh")
def _silu(x):
    return torch.nn.functional.silu(x)
def _sigmoid(x):
    return torch.sigmoid(x)
def _layernorm(x, axis=-1, eps=1e-5):
    m = x.mean(dim=axis, keepdim=True)
    v = x.var(dim=axis, keepdim=True, unbiased=False)
    return (x - m) / torch.sqrt(v + eps)
def _scatter_add(tgt, idx, src, axis=0):
    return tgt.clone().index_add_(axis, idx, src)
def _segment_sum(src, seg, n):
    out = torch.zeros((n,) + src.shape[1:], dtype=src.dtype)
    return out.index_add_(0, seg, src)
def _pad(x, pw):
    flat = tuple(v for pair in reversed(pw) for v in pair)
    return torch.nn.functional.pad(x, flat)

kernel_name = 'concat_heads__gqa_block_cached__sliding_block_cached__decode'

def setup_inputs():

    _w = (lambda a: (lambda t: t.to(torch.bfloat16) if t.is_floating_point() else t)(torch.as_tensor(a)))
    def _A_setup():
        B, Sq, D = 1, 1, 512
        Hq, Hkv, Sk, Dh = 32, 8, 65536, 128
        assert Hq % Hkv == 0, (Hq, Hkv)
        return {
            "x": _w((lambda *s: torch.randn(*s, dtype=torch.bfloat16) * 0.4)(B, Sq, D)),
            "k_cache": _w((lambda *s: torch.randn(*s, dtype=torch.bfloat16) * 3.2)(B, Hkv, Sk, Dh)),
            "v_cache": _w((lambda *s: torch.randn(*s, dtype=torch.bfloat16) * 0.8)(B, Hkv, Sk, Dh)),
            "wq": _w((lambda *s: torch.randn(*s, dtype=torch.bfloat16) * 3.2)(D, Hq * Dh) * (D ** -0.5)),
            "wo": _w((lambda *s: torch.randn(*s, dtype=torch.bfloat16) * 0.8)(Hq * Dh, D) * ((Hq * Dh) ** -0.5)),
        }
    _A_in = _A_setup()

    def _B_setup():
        B, Sq, D = 1, 1, 512
        Hq, Hkv, Sk, Dh = 32, 8, 65536, 128
        assert Hq % Hkv == 0, (Hq, Hkv)
        return {
            "x": _w((lambda *s: torch.randn(*s, dtype=torch.bfloat16) * 0.2)(B, Sq, D)),
            "k_cache": _w((lambda *s: torch.randn(*s, dtype=torch.bfloat16) * 3.2)(B, Hkv, Sk, Dh)),
            "v_cache": _w((lambda *s: torch.randn(*s, dtype=torch.bfloat16) * 1.6)(B, Hkv, Sk, Dh)),
            "wq": _w((lambda *s: torch.randn(*s, dtype=torch.bfloat16) * 3.2)(D, Hq * Dh) * (D ** -0.5)),
            "wo": _w((lambda *s: torch.randn(*s, dtype=torch.bfloat16) * 1.6)(Hq * Dh, D) * ((Hq * Dh) ** -0.5)),
        }
    _B_in = _B_setup()

    return {
        "A_x": _A_in["x"],
        "A_k_cache": _A_in["k_cache"],
        "A_v_cache": _A_in["v_cache"],
        "A_wq": _A_in["wq"],
        "A_wo": _A_in["wo"],
        "B_x": _B_in["x"],
        "B_k_cache": _B_in["k_cache"],
        "B_v_cache": _B_in["v_cache"],
        "B_wq": _B_in["wq"],
        "B_wo": _B_in["wo"],
    }

def reference(A_x, A_k_cache, A_v_cache, A_wq, A_wo, B_x, B_k_cache, B_v_cache, B_wq, B_wo):
    def _A_ref(x, k_cache, v_cache, wq, wo):
        B, Sq, D = x.shape
        Hq, Dh = 32, 128
        Hkv = k_cache.shape[1]
        rep = Hq // Hkv
        q = (lambda x, *d: x.permute(*d))((x @ wq).reshape(B, Sq, Hq, Dh), 0, 2, 1, 3)
        k = (lambda x, n, axis: torch.repeat_interleave(x, n, dim=axis))(k_cache, rep, axis=1)
        v = (lambda x, n, axis: torch.repeat_interleave(x, n, dim=axis))(v_cache, rep, axis=1)
        scores = torch.einsum("bhqd,bhkd->bhqk", q, k) * (Dh ** -0.5)
        p = _softmax(scores, axis=-1)
        o = torch.einsum("bhqk,bhkd->bhqd", p, v)
        return (lambda x, *d: x.permute(*d))(o, 0, 2, 1, 3).reshape(B, Sq, Hq * Dh) @ wo

    def _B_ref(x, k_cache, v_cache, wq, wo):
        B, Sq, D = x.shape
        Hq, Dh = 32, 128
        Hkv, Sk = k_cache.shape[1], k_cache.shape[2]
        W = min(4096, max(256, Sk // 4))
        rep = Hq // Hkv
        q = (lambda x, *d: x.permute(*d))((x @ wq).reshape(B, Sq, Hq, Dh), 0, 2, 1, 3)
        k = (lambda x, n, axis: torch.repeat_interleave(x, n, dim=axis))(k_cache[:, :, Sk - W:, :], rep, axis=1)
        v = (lambda x, n, axis: torch.repeat_interleave(x, n, dim=axis))(v_cache[:, :, Sk - W:, :], rep, axis=1)
        scores = torch.einsum("bhqd,bhkd->bhqk", q, k) * (Dh ** -0.5)
        p = _softmax(scores, axis=-1)
        o = torch.einsum("bhqk,bhkd->bhqd", p, v)
        return (lambda x, *d: x.permute(*d))(o, 0, 2, 1, 3).reshape(B, Sq, Hq * Dh) @ wo

    a = _A_ref(A_x, A_k_cache, A_v_cache, A_wq, A_wo)
    b = _B_ref(B_x, B_k_cache, B_v_cache, B_wq, B_wo)
    return torch.concatenate([a, b], axis=-1)
```

```asm
; @launch grid=(256,1,1) block=(256,1,1) lds=19968
.amdgcn_target "amdgcn-amd-amdhsa--gfx950"
.text
.globl concat_heads__gqa_block_cached__sliding_block_cached__decode_kernel
.p2align 8
.type concat_heads__gqa_block_cached__sliding_block_cached__decode_kernel,@function
concat_heads__gqa_block_cached__sliding_block_cached__decode_kernel:
  s_cmp_ge_u32 s2, 256
  s_cbranch_scc1 L_end
  s_load_dwordx16 s[40:55], s[0:1], 0
  s_load_dwordx8 s[56:63], s[0:1], 64
  s_load_dwordx2 s[64:65], s[0:1], 96
  v_lshrrev_b32 v1, 6, v0
  v_and_b32 v2, 63, v0
  v_readfirstlane_b32 s3, v1
  s_lshr_b32 s4, s2, 5
  s_and_b32 s5, s2, 7
  s_lshl_b32 s5, s5, 1
  s_bfe_u32 s34, s2, 0x10003
  s_add_u32 s5, s5, s34
  s_and_b32 s34, s2, 16
  s_add_u32 s5, s5, s34
  s_mov_b32 s30, 0x05040100
  s_mov_b32 s31, 0x07060302
  s_mov_b32 s32, 0x3db504f3
  s_mov_b32 s33, 0x3fb8aa3b
  s_lshl_b32 s34, s4, 10
  s_add_u32 s35, s5, 0
  s_and_b32 s35, s35, 15
  s_lshl_b32 s35, s35, 6
  s_add_u32 s34, s34, s35
  s_lshl_b32 s35, s3, 20
  s_add_u32 s34, s34, s35
  v_lshrrev_b32 v8, 2, v2
  v_lshlrev_b32 v7, 16, v8
  v_and_b32 v9, 3, v2
  v_lshl_add_u32 v7, v9, 4, v7
  v_lshlrev_b32 v8, 4, v8
  s_lshl_b32 s37, s3, 8
  v_and_b32 v9, 3, v2
  v_lshlrev_b32 v9, 10, v9
  v_bfe_u32 v10, v2, 2, 2
  v_lshl_add_u32 v9, v10, 8, v9
  v_lshrrev_b32 v10, 4, v2
  v_lshl_add_u32 v3, v10, 4, v9
  v_add_u32 v4, 0x1000, v3
  v_lshlrev_b32 v5, 4, v2
  v_add_u32 v6, 0x1000, v5
  s_lshl_b32 s36, s4, 24
  s_lshl_b32 s35, s3, 13
  s_add_u32 s36, s36, s35
  s_lshl_b32 s35, s5, 15
  s_add_u32 s28, s36, s35
  s_add_u32 s28, s28, 15728640
  s_mov_b32 s7, s28
  s_lshl_b32 s35, s5, 19
  s_add_u32 s72, s36, s35
  s_waitcnt lgkmcnt(0)
  s_mov_b32 s16, s64
  s_mov_b32 s17, s65
  s_mov_b32 s18, 0x400000
  s_mov_b32 s19, 0x20000
  s_cmp_ge_u32 s5, 16
  s_cselect_b32 s24, s56, s46
  s_cselect_b32 s25, s57, s47
  s_mov_b32 s26, 0x400000
  s_mov_b32 s27, 0x20000
  s_cselect_b32 s20, s50, s40
  s_cselect_b32 s21, s51, s41
  s_mov_b32 s22, 0x400
  s_mov_b32 s23, 0x20000
  buffer_load_dwordx4 v[32:35], v7, s[24:27], s34 offen nt
  s_add_u32 s34, s34, 8192
  buffer_load_dwordx4 v[36:39], v7, s[24:27], s34 offen nt
  s_add_u32 s34, s34, 8192
  buffer_load_dwordx4 v[40:43], v7, s[24:27], s34 offen nt
  s_add_u32 s34, s34, 8192
  buffer_load_dwordx4 v[44:47], v7, s[24:27], s34 offen nt
  s_add_u32 s34, s34, 8192
  buffer_load_dwordx4 v[48:51], v7, s[24:27], s34 offen nt
  s_add_u32 s34, s34, 8192
  buffer_load_dwordx4 v[52:55], v7, s[24:27], s34 offen nt
  s_add_u32 s34, s34, 8192
  buffer_load_dwordx4 v[56:59], v7, s[24:27], s34 offen nt
  s_add_u32 s34, s34, 8192
  buffer_load_dwordx4 v[60:63], v7, s[24:27], s34 offen nt
  buffer_load_dwordx4 v[64:67], v8, s[20:23], s37 offen
  buffer_load_dword v14, off, s[16:19], 0 sc1
  s_mov_b32 s8, s52
  s_mov_b32 s9, s53
  s_mov_b32 s10, 0x8000000
  s_mov_b32 s11, 0x20000
  s_mov_b32 s12, s54
  s_mov_b32 s13, s55
  s_mov_b32 s14, 0x8000000
  s_mov_b32 s15, 0x20000
  s_barrier
  buffer_load_dwordx4 a[0:3], v3, s[8:11], s28 offen offset:0 nt
  buffer_load_dwordx4 a[4:7], v3, s[8:11], s28 offen offset:64 nt
  buffer_load_dwordx4 a[8:11], v3, s[8:11], s28 offen offset:128 nt
  buffer_load_dwordx4 a[12:15], v3, s[8:11], s28 offen offset:192 nt
  buffer_load_dwordx4 a[16:19], v4, s[8:11], s28 offen offset:0 nt
  buffer_load_dwordx4 a[20:23], v4, s[8:11], s28 offen offset:64 nt
  buffer_load_dwordx4 a[24:27], v4, s[8:11], s28 offen offset:128 nt
  buffer_load_dwordx4 a[28:31], v4, s[8:11], s28 offen offset:192 nt
  s_mov_b32 s8, s42
  s_mov_b32 s9, s43
  s_mov_b32 s28, s72
  s_lshr_b32 s71, s5, 4
  s_lshl_b32 s71, s71, 3
  s_add_u32 s71, s71, s4
  s_lshl_b32 s71, s71, 11
  s_and_b32 s35, s5, 15
  s_lshl_b32 s35, s35, 7
  s_add_u32 s71, s71, s35
  s_add_u32 s71, s71, 4096
  v_and_b32 v12, 3, v2
  v_lshlrev_b32 v12, 5, v12
  v_lshrrev_b32 v13, 4, v2
  v_lshl_add_u32 v12, v13, 3, v12
  s_lshl_b32 s35, s3, 7
  v_add_u32 v12, s35, v12
  s_lshl_b32 s36, s4, 11
  s_lshl_b32 s35, s3, 9
  s_add_u32 s36, s36, s35
  s_add_u32 s36, s36, 4096
  s_add_u32 s37, s36, 0x4000
  v_lshlrev_b32 v13, 3, v2
  v_and_b32 v7, 3, v2
  v_lshrrev_b32 v8, 4, v2
  v_lshlrev_b32 v9, 8, v7
  v_lshl_add_u32 v9, v8, 4, v9
  v_lshl_add_u32 v10, v7, 2, v8
  v_lshlrev_b32 v10, 4, v10
  s_mul_i32 s34, s3, 2176
  v_add_u32 v10, s34, v10
  s_lshl_b32 s34, s3, 2
  v_lshlrev_b32 v11, 4, v7
  v_add_u32 v11, s34, v11
  s_mov_b32 s66, 0x7060500
  s_mov_b32 s67, 0x7060501
  s_mov_b32 s68, 0x7060502
  s_mov_b32 s69, 0x7060503
  s_mov_b32 s70, 0x0c0c0400
  s_waitcnt vmcnt(8)
  v_add_u32 v14, 0x9e3779b9, v14
  v_perm_b32 v76, v36, v32, s30
  v_perm_b32 v77, v36, v32, s31
  v_dot2_f32_bf16 v68, v76, v64, 0
  v_dot2_f32_bf16 v69, v77, v64, 0
  v_perm_b32 v78, v37, v33, s30
  v_perm_b32 v79, v37, v33, s31
  v_dot2_f32_bf16 v70, v78, v64, 0
  v_dot2_f32_bf16 v71, v79, v64, 0
  v_perm_b32 v80, v38, v34, s30
  v_perm_b32 v81, v38, v34, s31
  v_dot2_f32_bf16 v72, v80, v64, 0
  v_dot2_f32_bf16 v73, v81, v64, 0
  v_perm_b32 v82, v39, v35, s30
  v_perm_b32 v83, v39, v35, s31
  v_dot2_f32_bf16 v74, v82, v64, 0
  v_dot2_f32_bf16 v75, v83, v64, 0
  v_perm_b32 v76, v44, v40, s30
  v_perm_b32 v77, v44, v40, s31
  v_dot2_f32_bf16 v68, v76, v65, v68
  v_dot2_f32_bf16 v69, v77, v65, v69
  v_perm_b32 v78, v45, v41, s30
  v_perm_b32 v79, v45, v41, s31
  v_dot2_f32_bf16 v70, v78, v65, v70
  v_dot2_f32_bf16 v71, v79, v65, v71
  v_perm_b32 v80, v46, v42, s30
  v_perm_b32 v81, v46, v42, s31
  v_dot2_f32_bf16 v72, v80, v65, v72
  v_dot2_f32_bf16 v73, v81, v65, v73
  v_perm_b32 v82, v47, v43, s30
  v_perm_b32 v83, v47, v43, s31
  v_dot2_f32_bf16 v74, v82, v65, v74
  v_dot2_f32_bf16 v75, v83, v65, v75
  v_perm_b32 v76, v52, v48, s30
  v_perm_b32 v77, v52, v48, s31
  v_dot2_f32_bf16 v68, v76, v66, v68
  v_dot2_f32_bf16 v69, v77, v66, v69
  v_perm_b32 v78, v53, v49, s30
  v_perm_b32 v79, v53, v49, s31
  v_dot2_f32_bf16 v70, v78, v66, v70
  v_dot2_f32_bf16 v71, v79, v66, v71
  v_perm_b32 v80, v54, v50, s30
  v_perm_b32 v81, v54, v50, s31
  v_dot2_f32_bf16 v72, v80, v66, v72
  v_dot2_f32_bf16 v73, v81, v66, v73
  v_perm_b32 v82, v55, v51, s30
  v_perm_b32 v83, v55, v51, s31
  v_dot2_f32_bf16 v74, v82, v66, v74
  v_dot2_f32_bf16 v75, v83, v66, v75
  v_perm_b32 v76, v60, v56, s30
  v_perm_b32 v77, v60, v56, s31
  v_dot2_f32_bf16 v68, v76, v67, v68
  v_dot2_f32_bf16 v69, v77, v67, v69
  v_perm_b32 v78, v61, v57, s30
  v_perm_b32 v79, v61, v57, s31
  v_dot2_f32_bf16 v70, v78, v67, v70
  v_dot2_f32_bf16 v71, v79, v67, v71
  v_perm_b32 v80, v62, v58, s30
  v_perm_b32 v81, v62, v58, s31
  v_dot2_f32_bf16 v72, v80, v67, v72
  v_dot2_f32_bf16 v73, v81, v67, v73
  v_perm_b32 v82, v63, v59, s30
  v_perm_b32 v83, v63, v59, s31
  v_dot2_f32_bf16 v74, v82, v67, v74
  v_dot2_f32_bf16 v75, v83, v67, v75
  s_nop 2
  v_permlane32_swap_b32 v68, v72
  v_permlane32_swap_b32 v69, v73
  v_permlane32_swap_b32 v70, v74
  v_permlane32_swap_b32 v71, v75
  v_add_f32 v68, v68, v72
  v_add_f32 v69, v69, v73
  v_add_f32 v70, v70, v74
  v_add_f32 v71, v71, v75
  s_nop 1
  v_permlane16_swap_b32 v68, v70
  v_permlane16_swap_b32 v69, v71
  v_add_f32 v68, v68, v70
  v_add_f32 v69, v69, v71
  s_nop 0
  v_add_f32_dpp v68, v68, v68 row_ror:8 row_mask:0xf bank_mask:0xf
  v_add_f32_dpp v69, v69, v69 row_ror:8 row_mask:0xf bank_mask:0xf
  s_nop 0
  v_add_f32_dpp v68, v68, v68 row_ror:4 row_mask:0xf bank_mask:0xf
  v_add_f32_dpp v69, v69, v69 row_ror:4 row_mask:0xf bank_mask:0xf
  s_mov_b32 exec_lo, 0x000f000f
  s_mov_b32 exec_hi, 0x000f000f
  ds_write_b64 v12, v[68:69] offset:2560
  s_mov_b64 exec, -1
  s_waitcnt lgkmcnt(0)
  s_barrier
  s_cmp_lg_u32 s3, 0
  s_cbranch_scc1 L_nopub
  s_mov_b64 exec, 0xffff
  ds_read_b64 v[76:77], v13 offset:2560
  ds_read_b64 v[78:79], v13 offset:2688
  ds_read_b64 v[80:81], v13 offset:2816
  ds_read_b64 v[82:83], v13 offset:2944
  s_waitcnt lgkmcnt(0)
  v_add_f32 v76, v76, v78
  v_add_f32 v77, v77, v79
  v_add_f32 v80, v80, v82
  v_add_f32 v81, v81, v83
  v_add_f32 v76, v76, v80
  v_add_f32 v77, v77, v81
  v_cvt_pk_bf16_f32 v76, v76, v77
  v_mov_b32 v77, v14
  buffer_store_dwordx2 v[76:77], v13, s[16:19], s71 offen sc1
  s_mov_b64 exec, -1
L_nopub:
  s_barrier
  s_cmp_ge_u32 s5, 16
  s_cselect_b32 s24, s58, s48
  s_cselect_b32 s25, s59, s49
  s_mov_b32 s26, 0x400000
  s_mov_b32 s27, 0x20000
  v_lshrrev_b32 v7, 4, v2
  v_lshlrev_b32 v7, 13, v7
  v_and_b32 v8, 15, v2
  v_lshl_add_u32 v7, v8, 4, v7
  s_lshl_b32 s34, s3, 8
  v_add_u32 v7, s34, v7
  v_add_u32 v8, 0x1000, v7
  s_lshl_b32 s35, s4, 19
  s_and_b32 s34, s5, 15
  s_lshl_b32 s34, s34, 15
  s_add_u32 s34, s35, s34
  buffer_load_dwordx4 v[160:163], v7, s[24:27], s34 offen offset:0 nt
  buffer_load_dwordx4 v[164:167], v7, s[24:27], s34 offen offset:1024 nt
  buffer_load_dwordx4 v[168:171], v7, s[24:27], s34 offen offset:2048 nt
  buffer_load_dwordx4 v[172:175], v7, s[24:27], s34 offen offset:3072 nt
  buffer_load_dwordx4 v[176:179], v8, s[24:27], s34 offen offset:0 nt
  buffer_load_dwordx4 v[180:183], v8, s[24:27], s34 offen offset:1024 nt
  buffer_load_dwordx4 v[184:187], v8, s[24:27], s34 offen offset:2048 nt
  buffer_load_dwordx4 v[188:191], v8, s[24:27], s34 offen offset:3072 nt
  v_mov_b32 v32, 0
  v_mov_b32 v33, 0
  v_mov_b32 v34, 0
  v_mov_b32 v35, 0
  v_mov_b32 v36, 0
  v_mov_b32 v37, 0
  v_mov_b32 v38, 0
  v_mov_b32 v39, 0
  v_mov_b32 v40, 0
  v_mov_b32 v41, 0
  v_mov_b32 v42, 0
  v_mov_b32 v43, 0
  v_mov_b32 v44, 0
  v_mov_b32 v45, 0
  v_mov_b32 v46, 0
  v_mov_b32 v47, 0
  v_mov_b32 v48, 0
  v_mov_b32 v49, 0
  v_mov_b32 v50, 0
  v_mov_b32 v51, 0
  v_mov_b32 v52, 0
  v_mov_b32 v53, 0
  v_mov_b32 v54, 0
  v_mov_b32 v55, 0
  v_mov_b32 v56, 0
  v_mov_b32 v57, 0
  v_mov_b32 v58, 0
  v_mov_b32 v59, 0
  v_mov_b32 v60, 0
  v_mov_b32 v61, 0
  v_mov_b32 v62, 0
  v_mov_b32 v63, 0
  v_mov_b32 v88, 0xff800000
  v_mov_b32 v89, 0
  v_mov_b32 v90, 0
  buffer_load_dwordx2 v[64:65], v13, s[16:19], s36 offen sc1
  buffer_load_dwordx2 v[66:67], v13, s[16:19], s37 offen sc1
  buffer_load_dwordx4 v[96:99], v5, s[12:15], s7 offen offset:0 nt
  buffer_load_dwordx4 v[100:103], v5, s[12:15], s7 offen offset:1024 nt
  buffer_load_dwordx4 v[104:107], v5, s[12:15], s7 offen offset:2048 nt
  buffer_load_dwordx4 v[108:111], v5, s[12:15], s7 offen offset:3072 nt
  buffer_load_dwordx4 v[112:115], v6, s[12:15], s7 offen offset:0 nt
  buffer_load_dwordx4 v[116:119], v6, s[12:15], s7 offen offset:1024 nt
  buffer_load_dwordx4 v[120:123], v6, s[12:15], s7 offen offset:2048 nt
  buffer_load_dwordx4 v[124:127], v6, s[12:15], s7 offen offset:3072 nt
  s_mov_b32 s12, s44
  s_mov_b32 s13, s45
  s_mov_b32 s7, s72
  s_waitcnt vmcnt(8)
  v_xor_b32 v68, v65, v14
  v_xor_b32 v69, v67, v14
  v_or_b32 v68, v68, v69
  v_cmp_ne_u32 vcc, 0, v68
  s_cbranch_vccz L_qok2
  buffer_load_dwordx2 v[64:65], v13, s[16:19], s36 offen sc1
  buffer_load_dwordx2 v[66:67], v13, s[16:19], s37 offen sc1
  buffer_load_dwordx4 a[32:35], v3, s[8:11], s28 offen offset:0 nt
  buffer_load_dwordx4 a[36:39], v3, s[8:11], s28 offen offset:64 nt
  buffer_load_dwordx4 a[40:43], v3, s[8:11], s28 offen offset:128 nt
  buffer_load_dwordx4 a[44:47], v3, s[8:11], s28 offen offset:192 nt
  buffer_load_dwordx4 a[48:51], v4, s[8:11], s28 offen offset:0 nt
  buffer_load_dwordx4 a[52:55], v4, s[8:11], s28 offen offset:64 nt
  buffer_load_dwordx4 a[56:59], v4, s[8:11], s28 offen offset:128 nt
  buffer_load_dwordx4 a[60:63], v4, s[8:11], s28 offen offset:192 nt
  s_add_u32 s28, s28, 0x8000
  s_waitcnt vmcnt(8)
  v_xor_b32 v68, v65, v14
  v_xor_b32 v69, v67, v14
  v_or_b32 v68, v68, v69
  v_cmp_ne_u32 vcc, 0, v68
  s_cbranch_vccz L_qok3
  buffer_load_dwordx2 v[64:65], v13, s[16:19], s36 offen sc1
  buffer_load_dwordx2 v[66:67], v13, s[16:19], s37 offen sc1
  buffer_load_dwordx4 v[128:131], v5, s[12:15], s7 offen offset:0 nt
  buffer_load_dwordx4 v[132:135], v5, s[12:15], s7 offen offset:1024 nt
  buffer_load_dwordx4 v[136:139], v5, s[12:15], s7 offen offset:2048 nt
  buffer_load_dwordx4 v[140:143], v5, s[12:15], s7 offen offset:3072 nt
  buffer_load_dwordx4 v[144:147], v6, s[12:15], s7 offen offset:0 nt
  buffer_load_dwordx4 v[148:151], v6, s[12:15], s7 offen offset:1024 nt
  buffer_load_dwordx4 v[152:155], v6, s[12:15], s7 offen offset:2048 nt
  buffer_load_dwordx4 v[156:159], v6, s[12:15], s7 offen offset:3072 nt
  s_add_u32 s7, s7, 0x8000
  s_waitcnt vmcnt(8)
  v_xor_b32 v68, v65, v14
  v_xor_b32 v69, v67, v14
  v_or_b32 v68, v68, v69
  v_cmp_ne_u32 vcc, 0, v68
  s_cbranch_vccz L_qok4
  s_mov_b32 s6, 65536
L_qpoll:
  buffer_load_dwordx2 v[64:65], v13, s[16:19], s36 offen sc1
  buffer_load_dwordx2 v[66:67], v13, s[16:19], s37 offen sc1
  s_sub_u32 s6, s6, 1
  s_waitcnt vmcnt(0)
  v_xor_b32 v68, v65, v14
  v_xor_b32 v69, v67, v14
  v_or_b32 v68, v68, v69
  v_cmp_ne_u32 vcc, 0, v68
  s_cmp_eq_u32 s6, 0
  s_cbranch_scc1 L_qok4
  s_cbranch_vccnz L_qpoll
  s_branch L_qok4
L_qok2:
  buffer_load_dwordx4 a[32:35], v3, s[8:11], s28 offen offset:0 nt
  buffer_load_dwordx4 a[36:39], v3, s[8:11], s28 offen offset:64 nt
  buffer_load_dwordx4 a[40:43], v3, s[8:11], s28 offen offset:128 nt
  buffer_load_dwordx4 a[44:47], v3, s[8:11], s28 offen offset:192 nt
  buffer_load_dwordx4 a[48:51], v4, s[8:11], s28 offen offset:0 nt
  buffer_load_dwordx4 a[52:55], v4, s[8:11], s28 offen offset:64 nt
  buffer_load_dwordx4 a[56:59], v4, s[8:11], s28 offen offset:128 nt
  buffer_load_dwordx4 a[60:63], v4, s[8:11], s28 offen offset:192 nt
  s_add_u32 s28, s28, 0x8000
L_qok3:
  buffer_load_dwordx4 v[128:131], v5, s[12:15], s7 offen offset:0 nt
  buffer_load_dwordx4 v[132:135], v5, s[12:15], s7 offen offset:1024 nt
  buffer_load_dwordx4 v[136:139], v5, s[12:15], s7 offen offset:2048 nt
  buffer_load_dwordx4 v[140:143], v5, s[12:15], s7 offen offset:3072 nt
  buffer_load_dwordx4 v[144:147], v6, s[12:15], s7 offen offset:0 nt
  buffer_load_dwordx4 v[148:151], v6, s[12:15], s7 offen offset:1024 nt
  buffer_load_dwordx4 v[152:155], v6, s[12:15], s7 offen offset:2048 nt
  buffer_load_dwordx4 v[156:159], v6, s[12:15], s7 offen offset:3072 nt
  s_add_u32 s7, s7, 0x8000
L_qok4:
  v_lshlrev_b32 v7, 2, v0
  ds_write_b32 v7, v64 offset:0
  ds_write_b32 v7, v66 offset:1024
  s_waitcnt lgkmcnt(0)
  s_barrier
  ds_read_b128 v[16:19], v9 offset:1024
  ds_read_b128 v[20:23], v9 offset:1088
  ds_read_b128 v[24:27], v9 offset:1152
  ds_read_b128 v[28:31], v9 offset:1216
  s_mov_b32 s29, 1
  s_waitcnt lgkmcnt(0)
  s_waitcnt vmcnt(24)
  v_mfma_f32_16x16x32_bf16 v[64:67], a[0:3], v[16:19], 0
  v_mfma_f32_16x16x32_bf16 v[68:71], a[16:19], v[16:19], 0
  v_mfma_f32_16x16x32_bf16 v[64:67], a[4:7], v[20:23], v[64:67]
  v_mfma_f32_16x16x32_bf16 v[68:71], a[20:23], v[20:23], v[68:71]
  v_mfma_f32_16x16x32_bf16 v[64:67], a[8:11], v[24:27], v[64:67]
  v_mfma_f32_16x16x32_bf16 v[68:71], a[24:27], v[24:27], v[68:71]
  v_mfma_f32_16x16x32_bf16 v[64:67], a[12:15], v[28:31], v[64:67]
  v_mfma_f32_16x16x32_bf16 v[68:71], a[28:31], v[28:31], v[68:71]
  buffer_load_dwordx4 a[0:3], v3, s[8:11], s28 offen offset:0 nt
  buffer_load_dwordx4 a[4:7], v3, s[8:11], s28 offen offset:64 nt
  buffer_load_dwordx4 a[8:11], v3, s[8:11], s28 offen offset:128 nt
  buffer_load_dwordx4 a[12:15], v3, s[8:11], s28 offen offset:192 nt
  buffer_load_dwordx4 a[16:19], v4, s[8:11], s28 offen offset:0 nt
  buffer_load_dwordx4 a[20:23], v4, s[8:11], s28 offen offset:64 nt
  buffer_load_dwordx4 a[24:27], v4, s[8:11], s28 offen offset:128 nt
  buffer_load_dwordx4 a[28:31], v4, s[8:11], s28 offen offset:192 nt
  s_nop 0
  v_cvt_pk_bf16_f32 v64, 0, v64
  v_cvt_pk_bf16_f32 v65, 0, v65
  v_cvt_pk_bf16_f32 v66, 0, v66
  v_cvt_pk_bf16_f32 v67, 0, v67
  v_cvt_pk_bf16_f32 v68, 0, v68
  v_cvt_pk_bf16_f32 v69, 0, v69
  v_cvt_pk_bf16_f32 v70, 0, v70
  v_cvt_pk_bf16_f32 v71, 0, v71
  v_mul_f32 v64, s32, v64
  v_mul_f32 v65, s32, v65
  v_mul_f32 v66, s32, v66
  v_mul_f32 v67, s32, v67
  v_mul_f32 v68, s32, v68
  v_mul_f32 v69, s32, v69
  v_mul_f32 v70, s32, v70
  v_mul_f32 v71, s32, v71
  v_cvt_pk_bf16_f32 v64, 0, v64
  v_cvt_pk_bf16_f32 v65, 0, v65
  v_cvt_pk_bf16_f32 v66, 0, v66
  v_cvt_pk_bf16_f32 v67, 0, v67
  v_cvt_pk_bf16_f32 v68, 0, v68
  v_cvt_pk_bf16_f32 v69, 0, v69
  v_cvt_pk_bf16_f32 v70, 0, v70
  v_cvt_pk_bf16_f32 v71, 0, v71
  v_max3_f32 v91, v64, v65, v66
  v_max3_f32 v92, v67, v68, v69
  v_max3_f32 v91, v91, v70, v71
  v_max_f32 v91, v91, v92
  v_cmp_gt_f32 vcc, v91, v88
  s_cbranch_vccz L_nors_1
  v_max_f32 v91, v91, v88
  v_mov_b32 v92, v91
  s_nop 1
  v_permlane32_swap_b32 v91, v92
  v_max_f32 v91, v91, v92
  v_mov_b32 v92, v91
  s_nop 1
  v_permlane16_swap_b32 v91, v92
  v_max_f32 v91, v91, v92
  v_sub_f32 v92, v88, v91
  v_mul_f32 v92, s33, v92
  v_exp_f32 v92, v92
  v_mov_b32 v88, v91
  v_mul_f32 v90, s33, v91
  v_mul_f32 v89, v89, v92
  v_mul_f32 v32, v32, v92
  v_mul_f32 v33, v33, v92
  v_mul_f32 v34, v34, v92
  v_mul_f32 v35, v35, v92
  v_mul_f32 v36, v36, v92
  v_mul_f32 v37, v37, v92
  v_mul_f32 v38, v38, v92
  v_mul_f32 v39, v39, v92
  v_mul_f32 v40, v40, v92
  v_mul_f32 v41, v41, v92
  v_mul_f32 v42, v42, v92
  v_mul_f32 v43, v43, v92
  v_mul_f32 v44, v44, v92
  v_mul_f32 v45, v45, v92
  v_mul_f32 v46, v46, v92
  v_mul_f32 v47, v47, v92
  v_mul_f32 v48, v48, v92
  v_mul_f32 v49, v49, v92
  v_mul_f32 v50, v50, v92
  v_mul_f32 v51, v51, v92
  v_mul_f32 v52, v52, v92
  v_mul_f32 v53, v53, v92
  v_mul_f32 v54, v54, v92
  v_mul_f32 v55, v55, v92
  v_mul_f32 v56, v56, v92
  v_mul_f32 v57, v57, v92
  v_mul_f32 v58, v58, v92
  v_mul_f32 v59, v59, v92
  v_mul_f32 v60, v60, v92
  v_mul_f32 v61, v61, v92
  v_mul_f32 v62, v62, v92
  v_mul_f32 v63, v63, v92
L_nors_1:
  v_fma_f32 v64, v64, s33, -v90
  v_fma_f32 v65, v65, s33, -v90
  v_fma_f32 v66, v66, s33, -v90
  v_fma_f32 v67, v67, s33, -v90
  v_fma_f32 v68, v68, s33, -v90
  v_fma_f32 v69, v69, s33, -v90
  v_fma_f32 v70, v70, s33, -v90
  v_fma_f32 v71, v71, s33, -v90
  v_exp_f32 v64, v64
  v_exp_f32 v65, v65
  v_exp_f32 v66, v66
  v_exp_f32 v67, v67
  v_exp_f32 v68, v68
  v_exp_f32 v69, v69
  v_exp_f32 v70, v70
  v_exp_f32 v71, v71
  s_nop 0
  v_cvt_pk_bf16_f32 v72, v64, v65
  v_cvt_pk_bf16_f32 v73, v66, v67
  v_cvt_pk_bf16_f32 v74, v68, v69
  v_cvt_pk_bf16_f32 v75, v70, v71
  v_add_f32 v91, v64, v65
  v_add_f32 v92, v66, v67
  v_add_f32 v93, v68, v69
  v_add_f32 v94, v70, v71
  v_add_f32 v91, v91, v92
  v_add_f32 v93, v93, v94
  v_add_f32 v91, v91, v93
  v_add_f32 v89, v89, v91
  s_waitcnt vmcnt(24)
  v_perm_b32 v76, v100, v96, s30
  v_perm_b32 v77, v108, v104, s30
  v_perm_b32 v78, v116, v112, s30
  v_perm_b32 v79, v124, v120, s30
  v_perm_b32 v80, v100, v96, s31
  v_perm_b32 v81, v108, v104, s31
  v_perm_b32 v82, v116, v112, s31
  v_perm_b32 v83, v124, v120, s31
  v_mfma_f32_16x16x32_bf16 v[32:35], v[76:79], v[72:75], v[32:35]
  v_perm_b32 v84, v101, v97, s30
  v_perm_b32 v85, v109, v105, s30
  v_perm_b32 v86, v117, v113, s30
  v_perm_b32 v87, v125, v121, s30
  v_mfma_f32_16x16x32_bf16 v[36:39], v[80:83], v[72:75], v[36:39]
  v_perm_b32 v76, v101, v97, s31
  v_perm_b32 v77, v109, v105, s31
  v_perm_b32 v78, v117, v113, s31
  v_perm_b32 v79, v125, v121, s31
  v_mfma_f32_16x16x32_bf16 v[40:43], v[84:87], v[72:75], v[40:43]
  v_perm_b32 v80, v102, v98, s30
  v_perm_b32 v81, v110, v106, s30
  v_perm_b32 v82, v118, v114, s30
  v_perm_b32 v83, v126, v122, s30
  v_mfma_f32_16x16x32_bf16 v[44:47], v[76:79], v[72:75], v[44:47]
  v_perm_b32 v84, v102, v98, s31
  v_perm_b32 v85, v110, v106, s31
  v_perm_b32 v86, v118, v114, s31
  v_perm_b32 v87, v126, v122, s31
  v_mfma_f32_16x16x32_bf16 v[48:51], v[80:83], v[72:75], v[48:51]
  v_perm_b32 v76, v103, v99, s30
  v_perm_b32 v77, v111, v107, s30
  v_perm_b32 v78, v119, v115, s30
  v_perm_b32 v79, v127, v123, s30
  v_mfma_f32_16x16x32_bf16 v[52:55], v[84:87], v[72:75], v[52:55]
  v_perm_b32 v80, v103, v99, s31
  v_perm_b32 v81, v111, v107, s31
  v_perm_b32 v82, v119, v115, s31
  v_perm_b32 v83, v127, v123, s31
  v_mfma_f32_16x16x32_bf16 v[56:59], v[76:79], v[72:75], v[56:59]
  s_nop 1
  v_mfma_f32_16x16x32_bf16 v[60:63], v[80:83], v[72:75], v[60:63]
  buffer_load_dwordx4 v[96:99], v5, s[12:15], s7 offen offset:0 nt
  buffer_load_dwordx4 v[100:103], v5, s[12:15], s7 offen offset:1024 nt
  buffer_load_dwordx4 v[104:107], v5, s[12:15], s7 offen offset:2048 nt
  buffer_load_dwordx4 v[108:111], v5, s[12:15], s7 offen offset:3072 nt
  buffer_load_dwordx4 v[112:115], v6, s[12:15], s7 offen offset:0 nt
  buffer_load_dwordx4 v[116:119], v6, s[12:15], s7 offen offset:1024 nt
  buffer_load_dwordx4 v[120:123], v6, s[12:15], s7 offen offset:2048 nt
  buffer_load_dwordx4 v[124:127], v6, s[12:15], s7 offen offset:3072 nt
  s_add_u32 s28, s28, 0x8000
  s_add_u32 s7, s7, 0x8000
  s_add_u32 s29, s29, 1
  ds_read_b128 v[16:19], v9 offset:0
  ds_read_b128 v[20:23], v9 offset:64
  ds_read_b128 v[24:27], v9 offset:128
  ds_read_b128 v[28:31], v9 offset:192
  s_lshl_b32 s34, s3, 4
  v_mov_b32 v0, s34
  v_and_b32 v13, 7, v2
  v_mul_u32_u24 v8, 272, v13
  v_bfe_u32 v12, v2, 3, 2
  v_lshl_add_u32 v8, v12, 4, v8
  s_lshl_b32 s34, s3, 6
  v_add_u32 v8, s34, v8
  v_lshlrev_b32 v95, 12, v12
  v_lshl_add_u32 v95, v13, 4, v95
  s_lshl_b32 s34, s4, 16
  s_lshl_b32 s35, s5, 7
  s_add_u32 s34, s34, s35
  s_lshl_b32 s35, s3, 14
  s_add_u32 s34, s34, s35
  s_add_u32 s34, s34, 655360
  s_lshl_b32 s35, s4, 11
  s_lshl_b32 s36, s5, 4
  s_add_u32 s35, s35, s36
  s_lshl_b32 s36, s3, 9
  s_add_u32 s35, s35, s36
  s_add_u32 s35, s35, 81920
  v_mov_b32 v91, v89
  s_nop 1
  v_permlane32_swap_b32 v89, v91
  v_add_f32 v89, v89, v91
  v_mov_b32 v91, v89
  s_nop 1
  v_permlane16_swap_b32 v89, v91
  v_add_f32 v89, v89, v91
  s_mov_b32 exec_lo, 0x000f000f
  s_mov_b32 exec_hi, 0x000f000f
  s_nop 3
  ds_write_b128 v10, v[32:35] offset:11264
  ds_write_b128 v10, v[36:39] offset:11536
  ds_write_b128 v10, v[40:43] offset:11808
  ds_write_b128 v10, v[44:47] offset:12080
  ds_write_b128 v10, v[48:51] offset:12352
  ds_write_b128 v10, v[52:55] offset:12624
  ds_write_b128 v10, v[56:59] offset:12896
  ds_write_b128 v10, v[60:63] offset:13168
  s_mov_b64 exec, 15
  ds_write_b32 v11, v88 offset:2112
  ds_write_b32 v11, v89 offset:2240
  s_mov_b64 exec, -1
  s_waitcnt lgkmcnt(0)
  s_barrier
  ds_read_b128 v[32:35], v0 offset:2112
  ds_read_b128 v[36:39], v0 offset:2240
  ds_read_b128 v[40:43], v8 offset:11264
  ds_read_b128 v[44:47], v8 offset:13440
  ds_read_b128 v[48:51], v8 offset:15616
  ds_read_b128 v[52:55], v8 offset:17792
  v_mov_b32 v70, v14
  v_mov_b32 v71, v14
  s_waitcnt lgkmcnt(4)
  v_max3_f32 v68, v32, v33, v34
  v_max_f32 v68, v68, v35
  v_sub_f32 v32, v32, v68
  v_sub_f32 v33, v33, v68
  v_sub_f32 v34, v34, v68
  v_sub_f32 v35, v35, v68
  v_mul_f32 v32, s33, v32
  v_mul_f32 v33, s33, v33
  v_mul_f32 v34, s33, v34
  v_mul_f32 v35, s33, v35
  v_exp_f32 v32, v32
  v_exp_f32 v33, v33
  v_exp_f32 v34, v34
  v_exp_f32 v35, v35
  s_nop 0
  v_mul_f32 v69, v32, v36
  v_fmac_f32 v69, v33, v37
  v_fmac_f32 v69, v34, v38
  v_fmac_f32 v69, v35, v39
  s_waitcnt lgkmcnt(0)
  v_mul_f32 v64, v32, v40
  v_mul_f32 v65, v32, v41
  v_mul_f32 v66, v32, v42
  v_mul_f32 v67, v32, v43
  v_fmac_f32 v64, v33, v44
  v_fmac_f32 v65, v33, v45
  v_fmac_f32 v66, v33, v46
  v_fmac_f32 v67, v33, v47
  v_fmac_f32 v64, v34, v48
  v_fmac_f32 v65, v34, v49
  v_fmac_f32 v66, v34, v50
  v_fmac_f32 v67, v34, v51
  v_fmac_f32 v64, v35, v52
  v_fmac_f32 v65, v35, v53
  v_fmac_f32 v66, v35, v54
  v_fmac_f32 v67, v35, v55
  v_perm_b32 v64, v64, v14, s66
  v_perm_b32 v65, v65, v14, s67
  v_perm_b32 v66, v66, v14, s68
  v_perm_b32 v67, v67, v14, s69
  s_mov_b32 exec_hi, 0
  buffer_store_dwordx4 v[64:67], v95, s[16:19], s34 offen sc1
  s_mov_b32 exec_lo, 1
  buffer_store_dwordx4 v[68:71], off, s[16:19], s35 sc1
  s_mov_b64 exec, -1
  v_mov_b32 v32, 0
  v_mov_b32 v33, 0
  v_mov_b32 v34, 0
  v_mov_b32 v35, 0
  v_mov_b32 v36, 0
  v_mov_b32 v37, 0
  v_mov_b32 v38, 0
  v_mov_b32 v39, 0
  v_mov_b32 v40, 0
  v_mov_b32 v41, 0
  v_mov_b32 v42, 0
  v_mov_b32 v43, 0
  v_mov_b32 v44, 0
  v_mov_b32 v45, 0
  v_mov_b32 v46, 0
  v_mov_b32 v47, 0
  v_mov_b32 v48, 0
  v_mov_b32 v49, 0
  v_mov_b32 v50, 0
  v_mov_b32 v51, 0
  v_mov_b32 v52, 0
  v_mov_b32 v53, 0
  v_mov_b32 v54, 0
  v_mov_b32 v55, 0
  v_mov_b32 v56, 0
  v_mov_b32 v57, 0
  v_mov_b32 v58, 0
  v_mov_b32 v59, 0
  v_mov_b32 v60, 0
  v_mov_b32 v61, 0
  v_mov_b32 v62, 0
  v_mov_b32 v63, 0
  v_mov_b32 v88, 0xff800000
  v_mov_b32 v89, 0
  v_mov_b32 v90, 0
  s_sub_u32 s34, s34, 524288
  s_sub_u32 s35, s35, 16384
  v_lshlrev_b32 v12, 4, v2
  v_lshrrev_b32 v13, 3, v2
  v_lshlrev_b32 v13, 4, v13
  s_lshr_b32 s36, s5, 4
  s_lshl_b32 s36, s36, 3
  s_add_u32 s36, s36, s4
  s_lshl_b32 s71, s36, 16
  s_and_b32 s37, s5, 15
  s_lshl_b32 s37, s37, 12
  s_add_u32 s71, s71, s37
  s_lshl_b32 s37, s3, 10
  s_add_u32 s71, s71, s37
  v_add_u32 v7, s37, v12
  s_add_u32 s71, s71, 131072
  s_lshl_b32 s72, s36, 11
  s_and_b32 s37, s5, 12
  s_lshl_b32 s37, s37, 7
  s_add_u32 s72, s72, s37
  s_lshl_b32 s37, s3, 7
  s_add_u32 s72, s72, s37
  v_add_u32 v9, s37, v13
  s_add_u32 s72, s72, 65536
  s_lshr_b32 s38, s5, 4
  s_lshl_b32 s38, s38, 18
  s_lshl_b32 s39, s3, 16
  s_add_u32 s38, s38, s39
  s_lshl_b32 s39, s4, 10
  s_add_u32 s38, s38, s39
  s_and_b32 s39, s5, 15
  s_lshl_b32 s39, s39, 6
  s_add_u32 s38, s38, s39
  s_add_u32 s38, s38, 1179648
  v_bfe_u32 v15, v2, 1, 3
  v_lshlrev_b32 v15, 13, v15
  v_and_b32 v76, 1, v2
  v_lshl_add_u32 v15, v76, 5, v15
  v_lshrrev_b32 v76, 5, v2
  v_lshl_add_u32 v15, v76, 4, v15
  v_perm_b32 v76, v164, v160, s30
  v_perm_b32 v164, v164, v160, s31
  v_mov_b32 v160, v76
  v_perm_b32 v77, v165, v161, s30
  v_perm_b32 v165, v165, v161, s31
  v_mov_b32 v161, v77
  v_perm_b32 v78, v166, v162, s30
  v_perm_b32 v166, v166, v162, s31
  v_mov_b32 v162, v78
  v_perm_b32 v79, v167, v163, s30
  v_perm_b32 v167, v167, v163, s31
  v_mov_b32 v163, v79
  v_perm_b32 v76, v172, v168, s30
  v_perm_b32 v172, v172, v168, s31
  v_mov_b32 v168, v76
  v_perm_b32 v77, v173, v169, s30
  v_perm_b32 v173, v173, v169, s31
  v_mov_b32 v169, v77
  v_perm_b32 v78, v174, v170, s30
  v_perm_b32 v174, v174, v170, s31
  v_mov_b32 v170, v78
  v_perm_b32 v79, v175, v171, s30
  v_perm_b32 v175, v175, v171, s31
  v_mov_b32 v171, v79
  v_perm_b32 v76, v180, v176, s30
  v_perm_b32 v180, v180, v176, s31
  v_mov_b32 v176, v76
  v_perm_b32 v77, v181, v177, s30
  v_perm_b32 v181, v181, v177, s31
  v_mov_b32 v177, v77
  v_perm_b32 v78, v182, v178, s30
  v_perm_b32 v182, v182, v178, s31
  v_mov_b32 v178, v78
  v_perm_b32 v79, v183, v179, s30
  v_perm_b32 v183, v183, v179, s31
  v_mov_b32 v179, v79
  v_perm_b32 v76, v188, v184, s30
  v_perm_b32 v188, v188, v184, s31
  v_mov_b32 v184, v76
  v_perm_b32 v77, v189, v185, s30
  v_perm_b32 v189, v189, v185, s31
  v_mov_b32 v185, v77
  v_perm_b32 v78, v190, v186, s30
  v_perm_b32 v190, v190, v186, s31
  v_mov_b32 v186, v78
  v_perm_b32 v79, v191, v187, s30
  v_perm_b32 v191, v191, v187, s31
  v_mov_b32 v187, v79
L_loop:
  s_waitcnt vmcnt(24)
  v_mfma_f32_16x16x32_bf16 v[64:67], a[32:35], v[16:19], 0
  v_mfma_f32_16x16x32_bf16 v[68:71], a[48:51], v[16:19], 0
  v_mfma_f32_16x16x32_bf16 v[64:67], a[36:39], v[20:23], v[64:67]
  v_mfma_f32_16x16x32_bf16 v[68:71], a[52:55], v[20:23], v[68:71]
  v_mfma_f32_16x16x32_bf16 v[64:67], a[40:43], v[24:27], v[64:67]
  v_mfma_f32_16x16x32_bf16 v[68:71], a[56:59], v[24:27], v[68:71]
  v_mfma_f32_16x16x32_bf16 v[64:67], a[44:47], v[28:31], v[64:67]
  v_mfma_f32_16x16x32_bf16 v[68:71], a[60:63], v[28:31], v[68:71]
  buffer_load_dwordx4 a[32:35], v3, s[8:11], s28 offen offset:0 nt
  buffer_load_dwordx4 a[36:39], v3, s[8:11], s28 offen offset:64 nt
  buffer_load_dwordx4 a[40:43], v3, s[8:11], s28 offen offset:128 nt
  buffer_load_dwordx4 a[44:47], v3, s[8:11], s28 offen offset:192 nt
  buffer_load_dwordx4 a[48:51], v4, s[8:11], s28 offen offset:0 nt
  buffer_load_dwordx4 a[52:55], v4, s[8:11], s28 offen offset:64 nt
  buffer_load_dwordx4 a[56:59], v4, s[8:11], s28 offen offset:128 nt
  buffer_load_dwordx4 a[60:63], v4, s[8:11], s28 offen offset:192 nt
  s_nop 0
  v_cvt_pk_bf16_f32 v64, 0, v64
  v_cvt_pk_bf16_f32 v65, 0, v65
  v_cvt_pk_bf16_f32 v66, 0, v66
  v_cvt_pk_bf16_f32 v67, 0, v67
  v_cvt_pk_bf16_f32 v68, 0, v68
  v_cvt_pk_bf16_f32 v69, 0, v69
  v_cvt_pk_bf16_f32 v70, 0, v70
  v_cvt_pk_bf16_f32 v71, 0, v71
  v_mul_f32 v64, s32, v64
  v_mul_f32 v65, s32, v65
  v_mul_f32 v66, s32, v66
  v_mul_f32 v67, s32, v67
  v_mul_f32 v68, s32, v68
  v_mul_f32 v69, s32, v69
  v_mul_f32 v70, s32, v70
  v_mul_f32 v71, s32, v71
  v_cvt_pk_bf16_f32 v64, 0, v64
  v_cvt_pk_bf16_f32 v65, 0, v65
  v_cvt_pk_bf16_f32 v66, 0, v66
  v_cvt_pk_bf16_f32 v67, 0, v67
  v_cvt_pk_bf16_f32 v68, 0, v68
  v_cvt_pk_bf16_f32 v69, 0, v69
  v_cvt_pk_bf16_f32 v70, 0, v70
  v_cvt_pk_bf16_f32 v71, 0, v71
  v_max3_f32 v91, v64, v65, v66
  v_max3_f32 v92, v67, v68, v69
  v_max3_f32 v91, v91, v70, v71
  v_max_f32 v91, v91, v92
  v_cmp_gt_f32 vcc, v91, v88
  s_cbranch_vccz L_nors_2
  v_max_f32 v91, v91, v88
  v_mov_b32 v92, v91
  s_nop 1
  v_permlane32_swap_b32 v91, v92
  v_max_f32 v91, v91, v92
  v_mov_b32 v92, v91
  s_nop 1
  v_permlane16_swap_b32 v91, v92
  v_max_f32 v91, v91, v92
  v_sub_f32 v92, v88, v91
  v_mul_f32 v92, s33, v92
  v_exp_f32 v92, v92
  v_mov_b32 v88, v91
  v_mul_f32 v90, s33, v91
  v_mul_f32 v89, v89, v92
  v_mul_f32 v32, v32, v92
  v_mul_f32 v33, v33, v92
  v_mul_f32 v34, v34, v92
  v_mul_f32 v35, v35, v92
  v_mul_f32 v36, v36, v92
  v_mul_f32 v37, v37, v92
  v_mul_f32 v38, v38, v92
  v_mul_f32 v39, v39, v92
  v_mul_f32 v40, v40, v92
  v_mul_f32 v41, v41, v92
  v_mul_f32 v42, v42, v92
  v_mul_f32 v43, v43, v92
  v_mul_f32 v44, v44, v92
  v_mul_f32 v45, v45, v92
  v_mul_f32 v46, v46, v92
  v_mul_f32 v47, v47, v92
  v_mul_f32 v48, v48, v92
  v_mul_f32 v49, v49, v92
  v_mul_f32 v50, v50, v92
  v_mul_f32 v51, v51, v92
  v_mul_f32 v52, v52, v92
  v_mul_f32 v53, v53, v92
  v_mul_f32 v54, v54, v92
  v_mul_f32 v55, v55, v92
  v_mul_f32 v56, v56, v92
  v_mul_f32 v57, v57, v92
  v_mul_f32 v58, v58, v92
  v_mul_f32 v59, v59, v92
  v_mul_f32 v60, v60, v92
  v_mul_f32 v61, v61, v92
  v_mul_f32 v62, v62, v92
  v_mul_f32 v63, v63, v92
L_nors_2:
  v_fma_f32 v64, v64, s33, -v90
  v_fma_f32 v65, v65, s33, -v90
  v_fma_f32 v66, v66, s33, -v90
  v_fma_f32 v67, v67, s33, -v90
  v_fma_f32 v68, v68, s33, -v90
  v_fma_f32 v69, v69, s33, -v90
  v_fma_f32 v70, v70, s33, -v90
  v_fma_f32 v71, v71, s33, -v90
  v_exp_f32 v64, v64
  v_exp_f32 v65, v65
  v_exp_f32 v66, v66
  v_exp_f32 v67, v67
  v_exp_f32 v68, v68
  v_exp_f32 v69, v69
  v_exp_f32 v70, v70
  v_exp_f32 v71, v71
  s_nop 0
  v_cvt_pk_bf16_f32 v72, v64, v65
  v_cvt_pk_bf16_f32 v73, v66, v67
  v_cvt_pk_bf16_f32 v74, v68, v69
  v_cvt_pk_bf16_f32 v75, v70, v71
  v_add_f32 v91, v64, v65
  v_add_f32 v92, v66, v67
  v_add_f32 v93, v68, v69
  v_add_f32 v94, v70, v71
  v_add_f32 v91, v91, v92
  v_add_f32 v93, v93, v94
  v_add_f32 v91, v91, v93
  v_add_f32 v89, v89, v91
  s_waitcnt vmcnt(24)
  v_perm_b32 v76, v132, v128, s30
  v_perm_b32 v77, v140, v136, s30
  v_perm_b32 v78, v148, v144, s30
  v_perm_b32 v79, v156, v152, s30
  v_perm_b32 v80, v132, v128, s31
  v_perm_b32 v81, v140, v136, s31
  v_perm_b32 v82, v148, v144, s31
  v_perm_b32 v83, v156, v152, s31
  v_mfma_f32_16x16x32_bf16 v[32:35], v[76:79], v[72:75], v[32:35]
  v_perm_b32 v84, v133, v129, s30
  v_perm_b32 v85, v141, v137, s30
  v_perm_b32 v86, v149, v145, s30
  v_perm_b32 v87, v157, v153, s30
  v_mfma_f32_16x16x32_bf16 v[36:39], v[80:83], v[72:75], v[36:39]
  v_perm_b32 v76, v133, v129, s31
  v_perm_b32 v77, v141, v137, s31
  v_perm_b32 v78, v149, v145, s31
  v_perm_b32 v79, v157, v153, s31
  v_mfma_f32_16x16x32_bf16 v[40:43], v[84:87], v[72:75], v[40:43]
  v_perm_b32 v80, v134, v130, s30
  v_perm_b32 v81, v142, v138, s30
  v_perm_b32 v82, v150, v146, s30
  v_perm_b32 v83, v158, v154, s30
  v_mfma_f32_16x16x32_bf16 v[44:47], v[76:79], v[72:75], v[44:47]
  v_perm_b32 v84, v134, v130, s31
  v_perm_b32 v85, v142, v138, s31
  v_perm_b32 v86, v150, v146, s31
  v_perm_b32 v87, v158, v154, s31
  v_mfma_f32_16x16x32_bf16 v[48:51], v[80:83], v[72:75], v[48:51]
  v_perm_b32 v76, v135, v131, s30
  v_perm_b32 v77, v143, v139, s30
  v_perm_b32 v78, v151, v147, s30
  v_perm_b32 v79, v159, v155, s30
  v_mfma_f32_16x16x32_bf16 v[52:55], v[84:87], v[72:75], v[52:55]
  v_perm_b32 v80, v135, v131, s31
  v_perm_b32 v81, v143, v139, s31
  v_perm_b32 v82, v151, v147, s31
  v_perm_b32 v83, v159, v155, s31
  v_mfma_f32_16x16x32_bf16 v[56:59], v[76:79], v[72:75], v[56:59]
  s_nop 1
  v_mfma_f32_16x16x32_bf16 v[60:63], v[80:83], v[72:75], v[60:63]
  buffer_load_dwordx4 v[128:131], v5, s[12:15], s7 offen offset:0 nt
  buffer_load_dwordx4 v[132:135], v5, s[12:15], s7 offen offset:1024 nt
  buffer_load_dwordx4 v[136:139], v5, s[12:15], s7 offen offset:2048 nt
  buffer_load_dwordx4 v[140:143], v5, s[12:15], s7 offen offset:3072 nt
  buffer_load_dwordx4 v[144:147], v6, s[12:15], s7 offen offset:0 nt
  buffer_load_dwordx4 v[148:151], v6, s[12:15], s7 offen offset:1024 nt
  buffer_load_dwordx4 v[152:155], v6, s[12:15], s7 offen offset:2048 nt
  buffer_load_dwordx4 v[156:159], v6, s[12:15], s7 offen offset:3072 nt
  s_add_u32 s28, s28, 0x8000
  s_add_u32 s7, s7, 0x8000
  s_add_u32 s29, s29, 1
  s_waitcnt vmcnt(24)
  v_mfma_f32_16x16x32_bf16 v[64:67], a[0:3], v[16:19], 0
  v_mfma_f32_16x16x32_bf16 v[68:71], a[16:19], v[16:19], 0
  v_mfma_f32_16x16x32_bf16 v[64:67], a[4:7], v[20:23], v[64:67]
  v_mfma_f32_16x16x32_bf16 v[68:71], a[20:23], v[20:23], v[68:71]
  v_mfma_f32_16x16x32_bf16 v[64:67], a[8:11], v[24:27], v[64:67]
  v_mfma_f32_16x16x32_bf16 v[68:71], a[24:27], v[24:27], v[68:71]
  v_mfma_f32_16x16x32_bf16 v[64:67], a[12:15], v[28:31], v[64:67]
  v_mfma_f32_16x16x32_bf16 v[68:71], a[28:31], v[28:31], v[68:71]
  buffer_load_dwordx4 a[0:3], v3, s[8:11], s28 offen offset:0 nt
  buffer_load_dwordx4 a[4:7], v3, s[8:11], s28 offen offset:64 nt
  buffer_load_dwordx4 a[8:11], v3, s[8:11], s28 offen offset:128 nt
  buffer_load_dwordx4 a[12:15], v3, s[8:11], s28 offen offset:192 nt
  buffer_load_dwordx4 a[16:19], v4, s[8:11], s28 offen offset:0 nt
  buffer_load_dwordx4 a[20:23], v4, s[8:11], s28 offen offset:64 nt
  buffer_load_dwordx4 a[24:27], v4, s[8:11], s28 offen offset:128 nt
  buffer_load_dwordx4 a[28:31], v4, s[8:11], s28 offen offset:192 nt
  s_nop 0
  v_cvt_pk_bf16_f32 v64, 0, v64
  v_cvt_pk_bf16_f32 v65, 0, v65
  v_cvt_pk_bf16_f32 v66, 0, v66
  v_cvt_pk_bf16_f32 v67, 0, v67
  v_cvt_pk_bf16_f32 v68, 0, v68
  v_cvt_pk_bf16_f32 v69, 0, v69
  v_cvt_pk_bf16_f32 v70, 0, v70
  v_cvt_pk_bf16_f32 v71, 0, v71
  v_mul_f32 v64, s32, v64
  v_mul_f32 v65, s32, v65
  v_mul_f32 v66, s32, v66
  v_mul_f32 v67, s32, v67
  v_mul_f32 v68, s32, v68
  v_mul_f32 v69, s32, v69
  v_mul_f32 v70, s32, v70
  v_mul_f32 v71, s32, v71
  v_cvt_pk_bf16_f32 v64, 0, v64
  v_cvt_pk_bf16_f32 v65, 0, v65
  v_cvt_pk_bf16_f32 v66, 0, v66
  v_cvt_pk_bf16_f32 v67, 0, v67
  v_cvt_pk_bf16_f32 v68, 0, v68
  v_cvt_pk_bf16_f32 v69, 0, v69
  v_cvt_pk_bf16_f32 v70, 0, v70
  v_cvt_pk_bf16_f32 v71, 0, v71
  v_max3_f32 v91, v64, v65, v66
  v_max3_f32 v92, v67, v68, v69
  v_max3_f32 v91, v91, v70, v71
  v_max_f32 v91, v91, v92
  v_cmp_gt_f32 vcc, v91, v88
  s_cbranch_vccz L_nors_3
  v_max_f32 v91, v91, v88
  v_mov_b32 v92, v91
  s_nop 1
  v_permlane32_swap_b32 v91, v92
  v_max_f32 v91, v91, v92
  v_mov_b32 v92, v91
  s_nop 1
  v_permlane16_swap_b32 v91, v92
  v_max_f32 v91, v91, v92
  v_sub_f32 v92, v88, v91
  v_mul_f32 v92, s33, v92
  v_exp_f32 v92, v92
  v_mov_b32 v88, v91
  v_mul_f32 v90, s33, v91
  v_mul_f32 v89, v89, v92
  v_mul_f32 v32, v32, v92
  v_mul_f32 v33, v33, v92
  v_mul_f32 v34, v34, v92
  v_mul_f32 v35, v35, v92
  v_mul_f32 v36, v36, v92
  v_mul_f32 v37, v37, v92
  v_mul_f32 v38, v38, v92
  v_mul_f32 v39, v39, v92
  v_mul_f32 v40, v40, v92
  v_mul_f32 v41, v41, v92
  v_mul_f32 v42, v42, v92
  v_mul_f32 v43, v43, v92
  v_mul_f32 v44, v44, v92
  v_mul_f32 v45, v45, v92
  v_mul_f32 v46, v46, v92
  v_mul_f32 v47, v47, v92
  v_mul_f32 v48, v48, v92
  v_mul_f32 v49, v49, v92
  v_mul_f32 v50, v50, v92
  v_mul_f32 v51, v51, v92
  v_mul_f32 v52, v52, v92
  v_mul_f32 v53, v53, v92
  v_mul_f32 v54, v54, v92
  v_mul_f32 v55, v55, v92
  v_mul_f32 v56, v56, v92
  v_mul_f32 v57, v57, v92
  v_mul_f32 v58, v58, v92
  v_mul_f32 v59, v59, v92
  v_mul_f32 v60, v60, v92
  v_mul_f32 v61, v61, v92
  v_mul_f32 v62, v62, v92
  v_mul_f32 v63, v63, v92
L_nors_3:
  v_fma_f32 v64, v64, s33, -v90
  v_fma_f32 v65, v65, s33, -v90
  v_fma_f32 v66, v66, s33, -v90
  v_fma_f32 v67, v67, s33, -v90
  v_fma_f32 v68, v68, s33, -v90
  v_fma_f32 v69, v69, s33, -v90
  v_fma_f32 v70, v70, s33, -v90
  v_fma_f32 v71, v71, s33, -v90
  v_exp_f32 v64, v64
  v_exp_f32 v65, v65
  v_exp_f32 v66, v66
  v_exp_f32 v67, v67
  v_exp_f32 v68, v68
  v_exp_f32 v69, v69
  v_exp_f32 v70, v70
  v_exp_f32 v71, v71
  s_nop 0
  v_cvt_pk_bf16_f32 v72, v64, v65
  v_cvt_pk_bf16_f32 v73, v66, v67
  v_cvt_pk_bf16_f32 v74, v68, v69
  v_cvt_pk_bf16_f32 v75, v70, v71
  v_add_f32 v91, v64, v65
  v_add_f32 v92, v66, v67
  v_add_f32 v93, v68, v69
  v_add_f32 v94, v70, v71
  v_add_f32 v91, v91, v92
  v_add_f32 v93, v93, v94
  v_add_f32 v91, v91, v93
  v_add_f32 v89, v89, v91
  s_waitcnt vmcnt(24)
  v_perm_b32 v76, v100, v96, s30
  v_perm_b32 v77, v108, v104, s30
  v_perm_b32 v78, v116, v112, s30
  v_perm_b32 v79, v124, v120, s30
  v_perm_b32 v80, v100, v96, s31
  v_perm_b32 v81, v108, v104, s31
  v_perm_b32 v82, v116, v112, s31
  v_perm_b32 v83, v124, v120, s31
  v_mfma_f32_16x16x32_bf16 v[32:35], v[76:79], v[72:75], v[32:35]
  v_perm_b32 v84, v101, v97, s30
  v_perm_b32 v85, v109, v105, s30
  v_perm_b32 v86, v117, v113, s30
  v_perm_b32 v87, v125, v121, s30
  v_mfma_f32_16x16x32_bf16 v[36:39], v[80:83], v[72:75], v[36:39]
  v_perm_b32 v76, v101, v97, s31
  v_perm_b32 v77, v109, v105, s31
  v_perm_b32 v78, v117, v113, s31
  v_perm_b32 v79, v125, v121, s31
  v_mfma_f32_16x16x32_bf16 v[40:43], v[84:87], v[72:75], v[40:43]
  v_perm_b32 v80, v102, v98, s30
  v_perm_b32 v81, v110, v106, s30
  v_perm_b32 v82, v118, v114, s30
  v_perm_b32 v83, v126, v122, s30
  v_mfma_f32_16x16x32_bf16 v[44:47], v[76:79], v[72:75], v[44:47]
  v_perm_b32 v84, v102, v98, s31
  v_perm_b32 v85, v110, v106, s31
  v_perm_b32 v86, v118, v114, s31
  v_perm_b32 v87, v126, v122, s31
  v_mfma_f32_16x16x32_bf16 v[48:51], v[80:83], v[72:75], v[48:51]
  v_perm_b32 v76, v103, v99, s30
  v_perm_b32 v77, v111, v107, s30
  v_perm_b32 v78, v119, v115, s30
  v_perm_b32 v79, v127, v123, s30
  v_mfma_f32_16x16x32_bf16 v[52:55], v[84:87], v[72:75], v[52:55]
  v_perm_b32 v80, v103, v99, s31
  v_perm_b32 v81, v111, v107, s31
  v_perm_b32 v82, v119, v115, s31
  v_perm_b32 v83, v127, v123, s31
  v_mfma_f32_16x16x32_bf16 v[56:59], v[76:79], v[72:75], v[56:59]
  s_nop 1
  v_mfma_f32_16x16x32_bf16 v[60:63], v[80:83], v[72:75], v[60:63]
  buffer_load_dwordx4 v[96:99], v5, s[12:15], s7 offen offset:0 nt
  buffer_load_dwordx4 v[100:103], v5, s[12:15], s7 offen offset:1024 nt
  buffer_load_dwordx4 v[104:107], v5, s[12:15], s7 offen offset:2048 nt
  buffer_load_dwordx4 v[108:111], v5, s[12:15], s7 offen offset:3072 nt
  buffer_load_dwordx4 v[112:115], v6, s[12:15], s7 offen offset:0 nt
  buffer_load_dwordx4 v[116:119], v6, s[12:15], s7 offen offset:1024 nt
  buffer_load_dwordx4 v[120:123], v6, s[12:15], s7 offen offset:2048 nt
  buffer_load_dwordx4 v[124:127], v6, s[12:15], s7 offen offset:3072 nt
  s_add_u32 s28, s28, 0x8000
  s_add_u32 s7, s7, 0x8000
  s_add_u32 s29, s29, 1
  s_cmp_eq_u32 s29, 16
  s_cbranch_scc0 L_loop
  s_waitcnt vmcnt(24)
  v_mfma_f32_16x16x32_bf16 v[64:67], a[32:35], v[16:19], 0
  v_mfma_f32_16x16x32_bf16 v[68:71], a[48:51], v[16:19], 0
  v_mfma_f32_16x16x32_bf16 v[64:67], a[36:39], v[20:23], v[64:67]
  v_mfma_f32_16x16x32_bf16 v[68:71], a[52:55], v[20:23], v[68:71]
  v_mfma_f32_16x16x32_bf16 v[64:67], a[40:43], v[24:27], v[64:67]
  v_mfma_f32_16x16x32_bf16 v[68:71], a[56:59], v[24:27], v[68:71]
  v_mfma_f32_16x16x32_bf16 v[64:67], a[44:47], v[28:31], v[64:67]
  v_mfma_f32_16x16x32_bf16 v[68:71], a[60:63], v[28:31], v[68:71]
  s_nop 7
  s_nop 0
  v_cvt_pk_bf16_f32 v64, 0, v64
  v_cvt_pk_bf16_f32 v65, 0, v65
  v_cvt_pk_bf16_f32 v66, 0, v66
  v_cvt_pk_bf16_f32 v67, 0, v67
  v_cvt_pk_bf16_f32 v68, 0, v68
  v_cvt_pk_bf16_f32 v69, 0, v69
  v_cvt_pk_bf16_f32 v70, 0, v70
  v_cvt_pk_bf16_f32 v71, 0, v71
  v_mul_f32 v64, s32, v64
  v_mul_f32 v65, s32, v65
  v_mul_f32 v66, s32, v66
  v_mul_f32 v67, s32, v67
  v_mul_f32 v68, s32, v68
  v_mul_f32 v69, s32, v69
  v_mul_f32 v70, s32, v70
  v_mul_f32 v71, s32, v71
  v_cvt_pk_bf16_f32 v64, 0, v64
  v_cvt_pk_bf16_f32 v65, 0, v65
  v_cvt_pk_bf16_f32 v66, 0, v66
  v_cvt_pk_bf16_f32 v67, 0, v67
  v_cvt_pk_bf16_f32 v68, 0, v68
  v_cvt_pk_bf16_f32 v69, 0, v69
  v_cvt_pk_bf16_f32 v70, 0, v70
  v_cvt_pk_bf16_f32 v71, 0, v71
  v_max3_f32 v91, v64, v65, v66
  v_max3_f32 v92, v67, v68, v69
  v_max3_f32 v91, v91, v70, v71
  v_max_f32 v91, v91, v92
  v_cmp_gt_f32 vcc, v91, v88
  s_cbranch_vccz L_nors_4
  v_max_f32 v91, v91, v88
  v_mov_b32 v92, v91
  s_nop 1
  v_permlane32_swap_b32 v91, v92
  v_max_f32 v91, v91, v92
  v_mov_b32 v92, v91
  s_nop 1
  v_permlane16_swap_b32 v91, v92
  v_max_f32 v91, v91, v92
  v_sub_f32 v92, v88, v91
  v_mul_f32 v92, s33, v92
  v_exp_f32 v92, v92
  v_mov_b32 v88, v91
  v_mul_f32 v90, s33, v91
  v_mul_f32 v89, v89, v92
  v_mul_f32 v32, v32, v92
  v_mul_f32 v33, v33, v92
  v_mul_f32 v34, v34, v92
  v_mul_f32 v35, v35, v92
  v_mul_f32 v36, v36, v92
  v_mul_f32 v37, v37, v92
  v_mul_f32 v38, v38, v92
  v_mul_f32 v39, v39, v92
  v_mul_f32 v40, v40, v92
  v_mul_f32 v41, v41, v92
  v_mul_f32 v42, v42, v92
  v_mul_f32 v43, v43, v92
  v_mul_f32 v44, v44, v92
  v_mul_f32 v45, v45, v92
  v_mul_f32 v46, v46, v92
  v_mul_f32 v47, v47, v92
  v_mul_f32 v48, v48, v92
  v_mul_f32 v49, v49, v92
  v_mul_f32 v50, v50, v92
  v_mul_f32 v51, v51, v92
  v_mul_f32 v52, v52, v92
  v_mul_f32 v53, v53, v92
  v_mul_f32 v54, v54, v92
  v_mul_f32 v55, v55, v92
  v_mul_f32 v56, v56, v92
  v_mul_f32 v57, v57, v92
  v_mul_f32 v58, v58, v92
  v_mul_f32 v59, v59, v92
  v_mul_f32 v60, v60, v92
  v_mul_f32 v61, v61, v92
  v_mul_f32 v62, v62, v92
  v_mul_f32 v63, v63, v92
L_nors_4:
  v_fma_f32 v64, v64, s33, -v90
  v_fma_f32 v65, v65, s33, -v90
  v_fma_f32 v66, v66, s33, -v90
  v_fma_f32 v67, v67, s33, -v90
  v_fma_f32 v68, v68, s33, -v90
  v_fma_f32 v69, v69, s33, -v90
  v_fma_f32 v70, v70, s33, -v90
  v_fma_f32 v71, v71, s33, -v90
  v_exp_f32 v64, v64
  v_exp_f32 v65, v65
  v_exp_f32 v66, v66
  v_exp_f32 v67, v67
  v_exp_f32 v68, v68
  v_exp_f32 v69, v69
  v_exp_f32 v70, v70
  v_exp_f32 v71, v71
  s_nop 0
  v_cvt_pk_bf16_f32 v72, v64, v65
  v_cvt_pk_bf16_f32 v73, v66, v67
  v_cvt_pk_bf16_f32 v74, v68, v69
  v_cvt_pk_bf16_f32 v75, v70, v71
  v_add_f32 v91, v64, v65
  v_add_f32 v92, v66, v67
  v_add_f32 v93, v68, v69
  v_add_f32 v94, v70, v71
  v_add_f32 v91, v91, v92
  v_add_f32 v93, v93, v94
  v_add_f32 v91, v91, v93
  v_add_f32 v89, v89, v91
  s_waitcnt vmcnt(16)
  v_perm_b32 v76, v132, v128, s30
  v_perm_b32 v77, v140, v136, s30
  v_perm_b32 v78, v148, v144, s30
  v_perm_b32 v79, v156, v152, s30
  v_perm_b32 v80, v132, v128, s31
  v_perm_b32 v81, v140, v136, s31
  v_perm_b32 v82, v148, v144, s31
  v_perm_b32 v83, v156, v152, s31
  v_mfma_f32_16x16x32_bf16 v[32:35], v[76:79], v[72:75], v[32:35]
  v_perm_b32 v84, v133, v129, s30
  v_perm_b32 v85, v141, v137, s30
  v_perm_b32 v86, v149, v145, s30
  v_perm_b32 v87, v157, v153, s30
  v_mfma_f32_16x16x32_bf16 v[36:39], v[80:83], v[72:75], v[36:39]
  v_perm_b32 v76, v133, v129, s31
  v_perm_b32 v77, v141, v137, s31
  v_perm_b32 v78, v149, v145, s31
  v_perm_b32 v79, v157, v153, s31
  v_mfma_f32_16x16x32_bf16 v[40:43], v[84:87], v[72:75], v[40:43]
  v_perm_b32 v80, v134, v130, s30
  v_perm_b32 v81, v142, v138, s30
  v_perm_b32 v82, v150, v146, s30
  v_perm_b32 v83, v158, v154, s30
  v_mfma_f32_16x16x32_bf16 v[44:47], v[76:79], v[72:75], v[44:47]
  v_perm_b32 v84, v134, v130, s31
  v_perm_b32 v85, v142, v138, s31
  v_perm_b32 v86, v150, v146, s31
  v_perm_b32 v87, v158, v154, s31
  v_mfma_f32_16x16x32_bf16 v[48:51], v[80:83], v[72:75], v[48:51]
  v_perm_b32 v76, v135, v131, s30
  v_perm_b32 v77, v143, v139, s30
  v_perm_b32 v78, v151, v147, s30
  v_perm_b32 v79, v159, v155, s30
  v_mfma_f32_16x16x32_bf16 v[52:55], v[84:87], v[72:75], v[52:55]
  v_perm_b32 v80, v135, v131, s31
  v_perm_b32 v81, v143, v139, s31
  v_perm_b32 v82, v151, v147, s31
  v_perm_b32 v83, v159, v155, s31
  v_mfma_f32_16x16x32_bf16 v[56:59], v[76:79], v[72:75], v[56:59]
  s_nop 1
  v_mfma_f32_16x16x32_bf16 v[60:63], v[80:83], v[72:75], v[60:63]
  s_waitcnt vmcnt(8)
  v_mfma_f32_16x16x32_bf16 v[64:67], a[0:3], v[16:19], 0
  v_mfma_f32_16x16x32_bf16 v[68:71], a[16:19], v[16:19], 0
  v_mfma_f32_16x16x32_bf16 v[64:67], a[4:7], v[20:23], v[64:67]
  v_mfma_f32_16x16x32_bf16 v[68:71], a[20:23], v[20:23], v[68:71]
  v_mfma_f32_16x16x32_bf16 v[64:67], a[8:11], v[24:27], v[64:67]
  v_mfma_f32_16x16x32_bf16 v[68:71], a[24:27], v[24:27], v[68:71]
  v_mfma_f32_16x16x32_bf16 v[64:67], a[12:15], v[28:31], v[64:67]
  v_mfma_f32_16x16x32_bf16 v[68:71], a[28:31], v[28:31], v[68:71]
  s_nop 7
  s_nop 0
  v_cvt_pk_bf16_f32 v64, 0, v64
  v_cvt_pk_bf16_f32 v65, 0, v65
  v_cvt_pk_bf16_f32 v66, 0, v66
  v_cvt_pk_bf16_f32 v67, 0, v67
  v_cvt_pk_bf16_f32 v68, 0, v68
  v_cvt_pk_bf16_f32 v69, 0, v69
  v_cvt_pk_bf16_f32 v70, 0, v70
  v_cvt_pk_bf16_f32 v71, 0, v71
  v_mul_f32 v64, s32, v64
  v_mul_f32 v65, s32, v65
  v_mul_f32 v66, s32, v66
  v_mul_f32 v67, s32, v67
  v_mul_f32 v68, s32, v68
  v_mul_f32 v69, s32, v69
  v_mul_f32 v70, s32, v70
  v_mul_f32 v71, s32, v71
  v_cvt_pk_bf16_f32 v64, 0, v64
  v_cvt_pk_bf16_f32 v65, 0, v65
  v_cvt_pk_bf16_f32 v66, 0, v66
  v_cvt_pk_bf16_f32 v67, 0, v67
  v_cvt_pk_bf16_f32 v68, 0, v68
  v_cvt_pk_bf16_f32 v69, 0, v69
  v_cvt_pk_bf16_f32 v70, 0, v70
  v_cvt_pk_bf16_f32 v71, 0, v71
  v_max3_f32 v91, v64, v65, v66
  v_max3_f32 v92, v67, v68, v69
  v_max3_f32 v91, v91, v70, v71
  v_max_f32 v91, v91, v92
  v_cmp_gt_f32 vcc, v91, v88
  s_cbranch_vccz L_nors_5
  v_max_f32 v91, v91, v88
  v_mov_b32 v92, v91
  s_nop 1
  v_permlane32_swap_b32 v91, v92
  v_max_f32 v91, v91, v92
  v_mov_b32 v92, v91
  s_nop 1
  v_permlane16_swap_b32 v91, v92
  v_max_f32 v91, v91, v92
  v_sub_f32 v92, v88, v91
  v_mul_f32 v92, s33, v92
  v_exp_f32 v92, v92
  v_mov_b32 v88, v91
  v_mul_f32 v90, s33, v91
  v_mul_f32 v89, v89, v92
  v_mul_f32 v32, v32, v92
  v_mul_f32 v33, v33, v92
  v_mul_f32 v34, v34, v92
  v_mul_f32 v35, v35, v92
  v_mul_f32 v36, v36, v92
  v_mul_f32 v37, v37, v92
  v_mul_f32 v38, v38, v92
  v_mul_f32 v39, v39, v92
  v_mul_f32 v40, v40, v92
  v_mul_f32 v41, v41, v92
  v_mul_f32 v42, v42, v92
  v_mul_f32 v43, v43, v92
  v_mul_f32 v44, v44, v92
  v_mul_f32 v45, v45, v92
  v_mul_f32 v46, v46, v92
  v_mul_f32 v47, v47, v92
  v_mul_f32 v48, v48, v92
  v_mul_f32 v49, v49, v92
  v_mul_f32 v50, v50, v92
  v_mul_f32 v51, v51, v92
  v_mul_f32 v52, v52, v92
  v_mul_f32 v53, v53, v92
  v_mul_f32 v54, v54, v92
  v_mul_f32 v55, v55, v92
  v_mul_f32 v56, v56, v92
  v_mul_f32 v57, v57, v92
  v_mul_f32 v58, v58, v92
  v_mul_f32 v59, v59, v92
  v_mul_f32 v60, v60, v92
  v_mul_f32 v61, v61, v92
  v_mul_f32 v62, v62, v92
  v_mul_f32 v63, v63, v92
L_nors_5:
  v_fma_f32 v64, v64, s33, -v90
  v_fma_f32 v65, v65, s33, -v90
  v_fma_f32 v66, v66, s33, -v90
  v_fma_f32 v67, v67, s33, -v90
  v_fma_f32 v68, v68, s33, -v90
  v_fma_f32 v69, v69, s33, -v90
  v_fma_f32 v70, v70, s33, -v90
  v_fma_f32 v71, v71, s33, -v90
  v_exp_f32 v64, v64
  v_exp_f32 v65, v65
  v_exp_f32 v66, v66
  v_exp_f32 v67, v67
  v_exp_f32 v68, v68
  v_exp_f32 v69, v69
  v_exp_f32 v70, v70
  v_exp_f32 v71, v71
  s_nop 0
  v_cvt_pk_bf16_f32 v72, v64, v65
  v_cvt_pk_bf16_f32 v73, v66, v67
  v_cvt_pk_bf16_f32 v74, v68, v69
  v_cvt_pk_bf16_f32 v75, v70, v71
  v_add_f32 v91, v64, v65
  v_add_f32 v92, v66, v67
  v_add_f32 v93, v68, v69
  v_add_f32 v94, v70, v71
  v_add_f32 v91, v91, v92
  v_add_f32 v93, v93, v94
  v_add_f32 v91, v91, v93
  v_add_f32 v89, v89, v91
  s_waitcnt vmcnt(0)
  v_perm_b32 v76, v100, v96, s30
  v_perm_b32 v77, v108, v104, s30
  v_perm_b32 v78, v116, v112, s30
  v_perm_b32 v79, v124, v120, s30
  v_perm_b32 v80, v100, v96, s31
  v_perm_b32 v81, v108, v104, s31
  v_perm_b32 v82, v116, v112, s31
  v_perm_b32 v83, v124, v120, s31
  v_mfma_f32_16x16x32_bf16 v[32:35], v[76:79], v[72:75], v[32:35]
  v_perm_b32 v84, v101, v97, s30
  v_perm_b32 v85, v109, v105, s30
  v_perm_b32 v86, v117, v113, s30
  v_perm_b32 v87, v125, v121, s30
  v_mfma_f32_16x16x32_bf16 v[36:39], v[80:83], v[72:75], v[36:39]
  v_perm_b32 v76, v101, v97, s31
  v_perm_b32 v77, v109, v105, s31
  v_perm_b32 v78, v117, v113, s31
  v_perm_b32 v79, v125, v121, s31
  v_mfma_f32_16x16x32_bf16 v[40:43], v[84:87], v[72:75], v[40:43]
  v_perm_b32 v80, v102, v98, s30
  v_perm_b32 v81, v110, v106, s30
  v_perm_b32 v82, v118, v114, s30
  v_perm_b32 v83, v126, v122, s30
  v_mfma_f32_16x16x32_bf16 v[44:47], v[76:79], v[72:75], v[44:47]
  v_perm_b32 v84, v102, v98, s31
  v_perm_b32 v85, v110, v106, s31
  v_perm_b32 v86, v118, v114, s31
  v_perm_b32 v87, v126, v122, s31
  v_mfma_f32_16x16x32_bf16 v[48:51], v[80:83], v[72:75], v[48:51]
  v_perm_b32 v76, v103, v99, s30
  v_perm_b32 v77, v111, v107, s30
  v_perm_b32 v78, v119, v115, s30
  v_perm_b32 v79, v127, v123, s30
  v_mfma_f32_16x16x32_bf16 v[52:55], v[84:87], v[72:75], v[52:55]
  v_perm_b32 v80, v103, v99, s31
  v_perm_b32 v81, v111, v107, s31
  v_perm_b32 v82, v119, v115, s31
  v_perm_b32 v83, v127, v123, s31
  v_mfma_f32_16x16x32_bf16 v[56:59], v[76:79], v[72:75], v[56:59]
  s_nop 1
  v_mfma_f32_16x16x32_bf16 v[60:63], v[80:83], v[72:75], v[60:63]
  s_nop 7
  s_nop 3
L_loopend:
  v_mov_b32 v91, v89
  s_nop 1
  v_permlane32_swap_b32 v89, v91
  v_add_f32 v89, v89, v91
  v_mov_b32 v91, v89
  s_nop 1
  v_permlane16_swap_b32 v89, v91
  v_add_f32 v89, v89, v91
  s_mov_b32 exec_lo, 0x000f000f
  s_mov_b32 exec_hi, 0x000f000f
  s_nop 3
  ds_write_b128 v10, v[32:35] offset:2560
  ds_write_b128 v10, v[36:39] offset:2832
  ds_write_b128 v10, v[40:43] offset:3104
  ds_write_b128 v10, v[44:47] offset:3376
  ds_write_b128 v10, v[48:51] offset:3648
  ds_write_b128 v10, v[52:55] offset:3920
  ds_write_b128 v10, v[56:59] offset:4192
  ds_write_b128 v10, v[60:63] offset:4464
  s_mov_b64 exec, 15
  ds_write_b32 v11, v88 offset:2048
  ds_write_b32 v11, v89 offset:2176
  s_mov_b64 exec, -1
  s_waitcnt lgkmcnt(0)
  s_barrier
  ds_read_b128 v[32:35], v0 offset:2048
  ds_read_b128 v[36:39], v0 offset:2176
  ds_read_b128 v[40:43], v8 offset:2560
  ds_read_b128 v[44:47], v8 offset:4736
  ds_read_b128 v[48:51], v8 offset:6912
  ds_read_b128 v[52:55], v8 offset:9088
  v_mov_b32 v70, v14
  v_mov_b32 v71, v14
  s_waitcnt lgkmcnt(4)
  v_max3_f32 v68, v32, v33, v34
  v_max_f32 v68, v68, v35
  v_sub_f32 v32, v32, v68
  v_sub_f32 v33, v33, v68
  v_sub_f32 v34, v34, v68
  v_sub_f32 v35, v35, v68
  v_mul_f32 v32, s33, v32
  v_mul_f32 v33, s33, v33
  v_mul_f32 v34, s33, v34
  v_mul_f32 v35, s33, v35
  v_exp_f32 v32, v32
  v_exp_f32 v33, v33
  v_exp_f32 v34, v34
  v_exp_f32 v35, v35
  s_nop 0
  v_mul_f32 v69, v32, v36
  v_fmac_f32 v69, v33, v37
  v_fmac_f32 v69, v34, v38
  v_fmac_f32 v69, v35, v39
  s_waitcnt lgkmcnt(0)
  v_mul_f32 v64, v32, v40
  v_mul_f32 v65, v32, v41
  v_mul_f32 v66, v32, v42
  v_mul_f32 v67, v32, v43
  v_fmac_f32 v64, v33, v44
  v_fmac_f32 v65, v33, v45
  v_fmac_f32 v66, v33, v46
  v_fmac_f32 v67, v33, v47
  v_fmac_f32 v64, v34, v48
  v_fmac_f32 v65, v34, v49
  v_fmac_f32 v66, v34, v50
  v_fmac_f32 v67, v34, v51
  v_fmac_f32 v64, v35, v52
  v_fmac_f32 v65, v35, v53
  v_fmac_f32 v66, v35, v54
  v_fmac_f32 v67, v35, v55
  v_perm_b32 v64, v64, v14, s66
  v_perm_b32 v65, v65, v14, s67
  v_perm_b32 v66, v66, v14, s68
  v_perm_b32 v67, v67, v14, s69
  s_mov_b32 exec_hi, 0
  buffer_store_dwordx4 v[64:67], v95, s[16:19], s34 offen sc1
  s_mov_b32 exec_lo, 1
  buffer_store_dwordx4 v[68:71], off, s[16:19], s35 sc1
  s_mov_b64 exec, -1
  s_mov_b32 s6, 65536
L_s2poll:
  buffer_load_dwordx4 v[96:99], v12, s[16:19], s71 offen sc1
  buffer_load_dwordx4 v[100:103], v13, s[16:19], s72 offen sc1
  s_sub_u32 s6, s6, 1
  s_waitcnt vmcnt(0)
  v_perm_b32 v76, v97, v96, s70
  v_perm_b32 v77, v99, v98, s70
  v_perm_b32 v76, v77, v76, s30
  v_xor_b32 v76, v76, v14
  v_xor_b32 v77, v102, v14
  v_xor_b32 v78, v103, v14
  v_or3_b32 v76, v76, v77, v78
  v_cmp_ne_u32 vcc, 0, v76
  s_cmp_eq_u32 s6, 0
  s_cbranch_scc1 L_s2done
  s_mov_b64 exec, vcc
  s_cbranch_vccnz L_s2poll
L_s2done:
  s_mov_b64 exec, -1
  ds_write_b128 v7, v[96:99] offset:11264
  ds_write_b64 v9, v[100:101] offset:15360
  s_waitcnt lgkmcnt(0)
  s_barrier
  ds_read_b64 v[16:17], v13 offset:15360
  ds_read_b64 v[20:21], v13 offset:15488
  ds_read_b64 v[24:25], v13 offset:15616
  ds_read_b64 v[28:29], v13 offset:15744
  ds_read_b128 v[32:35], v12 offset:11264
  ds_read_b128 v[36:39], v12 offset:12288
  ds_read_b128 v[40:43], v12 offset:13312
  ds_read_b128 v[44:47], v12 offset:14336
  s_waitcnt lgkmcnt(4)
  v_max3_f32 v48, v16, v20, v24
  v_max_f32 v48, v48, v28
  s_nop 1
  v_max_f32_dpp v48, v48, v48 row_ror:8 row_mask:0xf bank_mask:0xf
  v_mov_b32 v49, v48
  s_nop 1
  v_permlane16_swap_b32 v48, v49
  v_max_f32 v48, v48, v49
  v_mov_b32 v49, v48
  s_nop 1
  v_permlane32_swap_b32 v48, v49
  v_max_f32 v48, v48, v49
  v_sub_f32 v16, v16, v48
  v_sub_f32 v20, v20, v48
  v_sub_f32 v24, v24, v48
  v_sub_f32 v28, v28, v48
  v_mul_f32 v16, s33, v16
  v_mul_f32 v20, s33, v20
  v_mul_f32 v24, s33, v24
  v_mul_f32 v28, s33, v28
  v_exp_f32 v16, v16
  v_exp_f32 v20, v20
  v_exp_f32 v24, v24
  v_exp_f32 v28, v28
  s_waitcnt lgkmcnt(0)
  v_mul_f32 v50, v16, v17
  v_mul_f32 v52, v16, v32
  v_mul_f32 v53, v16, v33
  v_mul_f32 v54, v16, v34
  v_mul_f32 v55, v16, v35
  v_fmac_f32 v50, v20, v21
  v_fmac_f32 v52, v20, v36
  v_fmac_f32 v53, v20, v37
  v_fmac_f32 v54, v20, v38
  v_fmac_f32 v55, v20, v39
  v_fmac_f32 v50, v24, v25
  v_fmac_f32 v52, v24, v40
  v_fmac_f32 v53, v24, v41
  v_fmac_f32 v54, v24, v42
  v_fmac_f32 v55, v24, v43
  v_fmac_f32 v50, v28, v29
  v_fmac_f32 v52, v28, v44
  v_fmac_f32 v53, v28, v45
  v_fmac_f32 v54, v28, v46
  v_fmac_f32 v55, v28, v47
  s_nop 1
  v_add_f32_dpp v50, v50, v50 row_ror:8 row_mask:0xf bank_mask:0xf
  v_mov_b32 v49, v50
  s_nop 1
  v_permlane16_swap_b32 v50, v49
  v_add_f32 v50, v50, v49
  v_mov_b32 v49, v50
  s_nop 1
  v_permlane32_swap_b32 v50, v49
  v_add_f32 v50, v50, v49
  v_rcp_f32 v50, v50
  v_permlane32_swap_b32 v52, v54
  v_permlane32_swap_b32 v53, v55
  v_add_f32 v52, v52, v54
  v_add_f32 v53, v53, v55
  s_nop 1
  v_permlane16_swap_b32 v52, v53
  v_add_f32 v52, v52, v53
  s_nop 1
  v_add_f32_dpp v52, v52, v52 row_ror:8 row_mask:0xf bank_mask:0xf
  v_mul_f32 v52, v52, v50
  s_nop 1
  v_mov_b32_dpp v64, v52 row_newbcast:0 row_mask:0xf bank_mask:0xf
  v_mov_b32_dpp v65, v52 row_newbcast:1 row_mask:0xf bank_mask:0xf
  v_mov_b32_dpp v66, v52 row_newbcast:2 row_mask:0xf bank_mask:0xf
  v_mov_b32_dpp v67, v52 row_newbcast:3 row_mask:0xf bank_mask:0xf
  v_mov_b32_dpp v68, v52 row_newbcast:4 row_mask:0xf bank_mask:0xf
  v_mov_b32_dpp v69, v52 row_newbcast:5 row_mask:0xf bank_mask:0xf
  v_mov_b32_dpp v70, v52 row_newbcast:6 row_mask:0xf bank_mask:0xf
  v_mov_b32_dpp v71, v52 row_newbcast:7 row_mask:0xf bank_mask:0xf
  v_cvt_pk_bf16_f32 v72, v64, v65
  v_cvt_pk_bf16_f32 v73, v66, v67
  v_cvt_pk_bf16_f32 v74, v68, v69
  v_cvt_pk_bf16_f32 v75, v70, v71
  v_dot2_f32_bf16 v64, v160, v72, 0
  v_dot2_f32_bf16 v65, v164, v72, 0
  v_dot2_f32_bf16 v66, v161, v72, 0
  v_dot2_f32_bf16 v67, v165, v72, 0
  v_dot2_f32_bf16 v68, v162, v72, 0
  v_dot2_f32_bf16 v69, v166, v72, 0
  v_dot2_f32_bf16 v70, v163, v72, 0
  v_dot2_f32_bf16 v71, v167, v72, 0
  v_dot2_f32_bf16 v64, v168, v73, v64
  v_dot2_f32_bf16 v65, v172, v73, v65
  v_dot2_f32_bf16 v66, v169, v73, v66
  v_dot2_f32_bf16 v67, v173, v73, v67
  v_dot2_f32_bf16 v68, v170, v73, v68
  v_dot2_f32_bf16 v69, v174, v73, v69
  v_dot2_f32_bf16 v70, v171, v73, v70
  v_dot2_f32_bf16 v71, v175, v73, v71
  v_dot2_f32_bf16 v64, v176, v74, v64
  v_dot2_f32_bf16 v65, v180, v74, v65
  v_dot2_f32_bf16 v66, v177, v74, v66
  v_dot2_f32_bf16 v67, v181, v74, v67
  v_dot2_f32_bf16 v68, v178, v74, v68
  v_dot2_f32_bf16 v69, v182, v74, v69
  v_dot2_f32_bf16 v70, v179, v74, v70
  v_dot2_f32_bf16 v71, v183, v74, v71
  v_dot2_f32_bf16 v64, v184, v75, v64
  v_dot2_f32_bf16 v65, v188, v75, v65
  v_dot2_f32_bf16 v66, v185, v75, v66
  v_dot2_f32_bf16 v67, v189, v75, v67
  v_dot2_f32_bf16 v68, v186, v75, v68
  v_dot2_f32_bf16 v69, v190, v75, v69
  v_dot2_f32_bf16 v70, v187, v75, v70
  v_dot2_f32_bf16 v71, v191, v75, v71
  s_nop 2
  v_permlane32_swap_b32 v64, v68
  v_permlane32_swap_b32 v65, v69
  v_permlane32_swap_b32 v66, v70
  v_permlane32_swap_b32 v67, v71
  v_add_f32 v64, v64, v68
  v_add_f32 v65, v65, v69
  v_add_f32 v66, v66, v70
  v_add_f32 v67, v67, v71
  v_mov_b32 v68, v64
  v_mov_b32 v69, v65
  v_mov_b32 v70, v66
  v_mov_b32 v71, v67
  v_permlane16_swap_b32 v64, v68
  v_permlane16_swap_b32 v65, v69
  v_permlane16_swap_b32 v66, v70
  v_permlane16_swap_b32 v67, v71
  v_add_f32 v64, v64, v68
  v_add_f32 v65, v65, v69
  v_add_f32 v66, v66, v70
  v_add_f32 v67, v67, v71
  v_perm_b32 v64, v64, v14, s66
  v_perm_b32 v65, v65, v14, s67
  v_perm_b32 v66, v66, v14, s68
  v_perm_b32 v67, v67, v14, s69
  s_mov_b32 exec_lo, 0xffff
  s_mov_b32 exec_hi, 0xffff
  buffer_store_dwordx4 v[64:67], v15, s[16:19], s38 offen sc1
  s_mov_b64 exec, -1
  s_and_b32 s34, s5, 17
  s_or_b32 s34, s34, s3
  s_cmp_lg_u32 s34, 0
  s_cbranch_scc1 L_fin
  s_lshl_b32 s29, s4, 2
  s_bfe_u32 s34, s5, 0x20002
  s_add_u32 s29, s29, s34
  s_bfe_u32 s34, s5, 0x10001
  s_lshl_b32 s34, s34, 5
  s_add_u32 s29, s29, s34
  v_lshlrev_b32 v12, 4, v2
  v_add_u32 v13, 0x1000, v12
  s_lshl_b32 s71, s29, 13
  s_add_u32 s71, s71, 1179648
  s_add_u32 s35, s71, 1024
  s_add_u32 s36, s71, 2048
  s_add_u32 s37, s71, 3072
  s_mov_b32 s20, s60
  s_mov_b32 s21, s61
  s_mov_b32 s22, 0x800
  s_mov_b32 s23, 0x20000
  s_lshl_b32 s39, s29, 5
  v_and_b32 v15, 3, v2
  v_lshlrev_b32 v15, 3, v15
  v_lshrrev_b32 v8, 5, v2
  v_lshl_add_u32 v15, v8, 2, v15
  s_mov_b32 s6, 65536
  s_mov_b64 s[40:41], -1
  s_mov_b64 s[42:43], -1
  s_mov_b64 s[44:45], -1
  s_mov_b64 s[46:47], -1
  s_mov_b64 s[48:49], -1
  s_mov_b64 s[50:51], -1
  s_mov_b64 s[52:53], -1
  s_mov_b64 s[54:55], -1
L_s3poll:
  s_mov_b64 exec, s[40:41]
  buffer_load_dwordx4 v[128:131], v12, s[16:19], s71 offen sc1
  s_mov_b64 exec, s[42:43]
  buffer_load_dwordx4 v[132:135], v12, s[16:19], s35 offen sc1
  s_mov_b64 exec, s[44:45]
  buffer_load_dwordx4 v[136:139], v12, s[16:19], s36 offen sc1
  s_mov_b64 exec, s[46:47]
  buffer_load_dwordx4 v[140:143], v12, s[16:19], s37 offen sc1
  s_mov_b64 exec, s[48:49]
  buffer_load_dwordx4 v[144:147], v13, s[16:19], s71 offen sc1
  s_mov_b64 exec, s[50:51]
  buffer_load_dwordx4 v[148:151], v13, s[16:19], s35 offen sc1
  s_mov_b64 exec, s[52:53]
  buffer_load_dwordx4 v[152:155], v13, s[16:19], s36 offen sc1
  s_mov_b64 exec, s[54:55]
  buffer_load_dwordx4 v[156:159], v13, s[16:19], s37 offen sc1
  s_mov_b64 exec, -1
  s_sub_u32 s6, s6, 1
  s_waitcnt vmcnt(7)
  v_perm_b32 v76, v129, v128, s70
  v_perm_b32 v84, v131, v130, s70
  v_perm_b32 v76, v84, v76, s30
  v_xor_b32 v76, v76, v14
  v_cmp_ne_u32 s[40:41], 0, v76
  s_waitcnt vmcnt(6)
  v_perm_b32 v77, v133, v132, s70
  v_perm_b32 v84, v135, v134, s70
  v_perm_b32 v77, v84, v77, s30
  v_xor_b32 v77, v77, v14
  v_cmp_ne_u32 s[42:43], 0, v77
  s_waitcnt vmcnt(5)
  v_perm_b32 v78, v137, v136, s70
  v_perm_b32 v84, v139, v138, s70
  v_perm_b32 v78, v84, v78, s30
  v_xor_b32 v78, v78, v14
  v_cmp_ne_u32 s[44:45], 0, v78
  s_waitcnt vmcnt(4)
  v_perm_b32 v79, v141, v140, s70
  v_perm_b32 v84, v143, v142, s70
  v_perm_b32 v79, v84, v79, s30
  v_xor_b32 v79, v79, v14
  v_cmp_ne_u32 s[46:47], 0, v79
  s_waitcnt vmcnt(3)
  v_perm_b32 v80, v145, v144, s70
  v_perm_b32 v84, v147, v146, s70
  v_perm_b32 v80, v84, v80, s30
  v_xor_b32 v80, v80, v14
  v_cmp_ne_u32 s[48:49], 0, v80
  s_waitcnt vmcnt(2)
  v_perm_b32 v81, v149, v148, s70
  v_perm_b32 v84, v151, v150, s70
  v_perm_b32 v81, v84, v81, s30
  v_xor_b32 v81, v81, v14
  v_cmp_ne_u32 s[50:51], 0, v81
  s_waitcnt vmcnt(1)
  v_perm_b32 v82, v153, v152, s70
  v_perm_b32 v84, v155, v154, s70
  v_perm_b32 v82, v84, v82, s30
  v_xor_b32 v82, v82, v14
  v_cmp_ne_u32 s[52:53], 0, v82
  s_waitcnt vmcnt(0)
  v_perm_b32 v83, v157, v156, s70
  v_perm_b32 v84, v159, v158, s70
  v_perm_b32 v83, v84, v83, s30
  v_xor_b32 v83, v83, v14
  v_cmp_ne_u32 s[54:55], 0, v83
  v_or3_b32 v76, v76, v77, v78
  v_or3_b32 v79, v79, v80, v81
  v_or3_b32 v76, v76, v82, v83
  v_or_b32 v76, v76, v79
  v_cmp_ne_u32 vcc, 0, v76
  s_cmp_eq_u32 s6, 0
  s_cbranch_scc1 L_s3done
  s_cbranch_vccnz L_s3poll
L_s3done:
  v_add_f32 v32, v128, v144
  v_add_f32 v33, v129, v145
  v_add_f32 v34, v130, v146
  v_add_f32 v35, v131, v147
  v_add_f32 v36, v132, v148
  v_add_f32 v37, v133, v149
  v_add_f32 v38, v134, v150
  v_add_f32 v39, v135, v151
  v_add_f32 v40, v136, v152
  v_add_f32 v41, v137, v153
  v_add_f32 v42, v138, v154
  v_add_f32 v43, v139, v155
  v_add_f32 v44, v140, v156
  v_add_f32 v45, v141, v157
  v_add_f32 v46, v142, v158
  v_add_f32 v47, v143, v159
  v_add_f32 v32, v32, v40
  v_add_f32 v33, v33, v41
  v_add_f32 v34, v34, v42
  v_add_f32 v35, v35, v43
  v_add_f32 v36, v36, v44
  v_add_f32 v37, v37, v45
  v_add_f32 v38, v38, v46
  v_add_f32 v39, v39, v47
  v_add_f32 v32, v32, v36
  v_add_f32 v33, v33, v37
  v_add_f32 v34, v34, v38
  v_add_f32 v35, v35, v39
  s_nop 1
  v_permlane32_swap_b32 v32, v34
  v_permlane32_swap_b32 v33, v35
  v_add_f32 v32, v32, v34
  v_add_f32 v33, v33, v35
  v_mov_b32 v34, v32
  v_mov_b32 v35, v33
  s_nop 1
  v_permlane16_swap_b32 v32, v34
  v_permlane16_swap_b32 v33, v35
  v_add_f32 v32, v32, v34
  v_add_f32 v33, v33, v35
  s_nop 0
  v_add_f32_dpp v32, v32, v32 row_ror:4 row_mask:0xf bank_mask:0xf
  v_add_f32_dpp v33, v33, v33 row_ror:4 row_mask:0xf bank_mask:0xf
  s_nop 0
  v_add_f32_dpp v32, v32, v32 row_ror:8 row_mask:0xf bank_mask:0xf
  v_add_f32_dpp v33, v33, v33 row_ror:8 row_mask:0xf bank_mask:0xf
  v_cvt_pk_bf16_f32 v32, v32, v33
  s_mov_b32 exec_lo, 15
  s_mov_b32 exec_hi, 15
  buffer_store_dword v32, v15, s[20:23], s39 offen
  s_mov_b64 exec, -1
  s_cmp_lg_u32 s29, 0
  s_cbranch_scc1 L_fin
  s_mov_b64 exec, 1
  buffer_store_dword v14, off, s[16:19], 0 sc1
  s_mov_b64 exec, -1
L_fin:
L_end:
  s_endpgm
.section .rodata,"a"
.p2align 6
.amdhsa_kernel concat_heads__gqa_block_cached__sliding_block_cached__decode_kernel
  .amdhsa_next_free_vgpr 256
  .amdhsa_next_free_sgpr 102
  .amdhsa_accum_offset 192
  .amdhsa_group_segment_fixed_size 0
  .amdhsa_kernarg_size 104
  .amdhsa_user_sgpr_count 2
  .amdhsa_user_sgpr_kernarg_segment_ptr 1
  .amdhsa_system_sgpr_workgroup_id_x 1
.end_amdhsa_kernel
```
